```python
import torch

def _softmax(x, axis=-1):
    return torch.softmax(x, dim=axis)
def _gelu(x):
    return torch.nn.functional.gelu(x, approximate="tanh")
def _silu(x):
    return torch.nn.functional.silu(x)
def _sigmoid(x):
    return torch.sigmoid(x)
def _layernorm(x, axis=-1, eps=1e-5):
    m = x.mean(dim=axis, keepdim=True)
    v = x.var(dim=axis, keepdim=True, unbiased=False)
    return (x - m) / torch.sqrt(v + eps)
def _scatter_add(tgt, idx, src, axis=0):
    return tgt.clone().index_add_(axis, idx, src)
def _segment_sum(src, seg, n):
    out = torch.zeros((n,) + src.shape[1:], dtype=src.dtype)
    return out.index_add_(0, seg, src)
def _pad(x, pw):
    flat = tuple(v for pair in reversed(pw) for v in pair)
    return torch.nn.functional.pad(x, flat)

kernel_name = 'recurrent_scan__linear_attn_block__dense_activation_silu__prompt'

def setup_inputs():

    _w = (lambda a: (lambda t: t.to(torch.bfloat16) if t.is_floating_point() else t)(torch.as_tensor(a)))
    def _A_setup():
        B, S, D = 1, 2048, 512
        return {
            "x": _w((lambda *s: torch.randn(*s, dtype=torch.bfloat16) * 0.05)(B, S, D)),
            "wqkv": _w((lambda *s: torch.randn(*s, dtype=torch.bfloat16) * 0.2)(D, 3 * D)),
            "wo": _w((lambda *s: torch.randn(*s, dtype=torch.bfloat16) * 0.2)(D, D)),
        }
    _A_in = _A_setup()

    def _B_setup():
        B, S, D, F = 1, 2048, 512, 1792
        return {
            "x": _w((lambda *s: torch.randn(*s, dtype=torch.bfloat16) * 0.05)(B, S, D)),
            "w1": _w((lambda *s: torch.randn(*s, dtype=torch.bfloat16) * 0.8)(D, F) * (D ** -0.5)),
            "w2": _w((lambda *s: torch.randn(*s, dtype=torch.bfloat16) * 0.1)(F, D) * (F ** -0.5)),
        }
    _B_in = _B_setup()

    return {
        "A_x": _A_in["x"],
        "A_wqkv": _A_in["wqkv"],
        "A_wo": _A_in["wo"],
        "B_x": _B_in["x"],
        "B_w1": _B_in["w1"],
        "B_w2": _B_in["w2"],
    }

def reference(A_x, A_wqkv, A_wo, B_x, B_w1, B_w2):
    def _A_ref(x, wqkv, wo):
        B, S, D = x.shape
        H = 32; Dh = D // H
        qkv = (lambda x, *d: x.permute(*d))((x @ wqkv).reshape(B, S, 3, H, Dh), 2, 0, 3, 1, 4)
        q, k, v = qkv[0], qkv[1], qkv[2]
        phi = lambda t: torch.where(t > 0, t + 1, torch.exp(t)) + 1e-6
        pq, pk = phi(q), phi(k)
        kv = torch.einsum("bhsd,bhse->bhde", pk, v)
        z = torch.einsum("bhsd->bhd", pk)
        num = torch.einsum("bhqd,bhde->bhqe", pq, kv)
        den = torch.einsum("bhqd,bhd->bhq", pq, z)[..., None] + 1e-6
        o = num / den
        return (lambda x, *d: x.permute(*d))(o, 0, 2, 1, 3).reshape(B, S, D) @ wo

    def _B_ref(x, w1, w2):
        h = torch.einsum("bsd,df->bsf", x, w1)
        h = _silu(h)
        out = torch.einsum("bsf,fd->bsd", h, w2)
        return out

    x = A_x
    xn = _layernorm(x, axis=-1)
    s = _A_ref(xn, A_wqkv, A_wo)
    g = _silu(_B_ref(xn, B_w1, B_w2))
    return x + s * g
```

```asm
; @launch grid=(256,1,1) block=(512,1,1) lds=163840
.amdgcn_target "amdgcn-amd-amdhsa--gfx950"
.text
.globl recurrent_scan__linear_attn_block__dense_activation_silu__prompt_kernel
.p2align 8
.type recurrent_scan__linear_attn_block__dense_activation_silu__prompt_kernel,@function
recurrent_scan__linear_attn_block__dense_activation_silu__prompt_kernel:
    s_cmp_ge_u32 s2, 256
    s_cbranch_scc1 L_end
    s_load_dwordx4 s[36:39], s[0:1], 0
    s_load_dwordx4 s[44:47], s[0:1], 32
    s_load_dwordx2 s[40:41], s[0:1], 16
    s_load_dwordx4 s[48:51], s[0:1], 48
    s_load_dwordx2 s[52:53], s[0:1], 64
    v_lshrrev_b32 v20, 6, v0
    v_and_b32 v21, 63, v0
    s_and_b32 s72, s2, 7
    v_readfirstlane_b32 s54, v20
    s_lshr_b32 s79, s2, 3
    s_and_b32 s74, s72, 1
    s_lshl_b32 s74, s74, 3
    s_and_b32 s75, s79, 7
    s_add_u32 s57, s74, s75
    s_lshr_b32 s74, s79, 3
    s_and_b32 s75, s72, 6
    s_and_b32 s95, s74, 1
    s_add_u32 s58, s75, s95
    s_lshl_b32 s59, s72, 2
    s_and_b32 s95, s79, 3
    s_add_u32 s59, s59, s95
    s_lshr_b32 s60, s79, 2
    s_cmp_lg_u32 s54, 7
    s_cbranch_scc1 L_cp_1
    s_getpc_b64 s[64:65]
L_pc:
    s_sub_u32 s64, s64, L_pc-recurrent_scan__linear_attn_block__dense_activation_silu__prompt_kernel
    s_subb_u32 s65, s65, 0
    s_mov_b32 s66, L_code_end-recurrent_scan__linear_attn_block__dense_activation_silu__prompt_kernel
    s_mov_b32 s67, 0x00020000
    s_and_b32 s73, s79, 15
    s_mul_i32 s73, s73, 2048
    v_lshlrev_b32 v72, 7, v21
    s_mov_b64 exec, 0xffff
    buffer_load_dword v0, v72, s[64:67], s73 offen
    s_mov_b64 exec, -1
L_cp_1:
    s_lshl_b32 s61, s54, 10
    s_lshl_b32 s62, s54, 12
    s_lshr_b32 s56, s54, 2
    s_lshl_b32 s63, s57, 17
    s_cmp_ge_u32 s74, 2
    s_cselect_b32 s77, 1, 0
    s_movk_i32 s96, 3584
    s_cselect_b32 s98, 3072, s96
    v_lshrrev_b32 v22, 3, v21
    v_and_b32 v23, 7, v21
    v_lshrrev_b32 v24, 1, v22
    s_lshl_b32 s95, s54, 2
    v_add_u32 v26, s95, v24
    v_and_b32 v26, 7, v26
    v_xor_b32 v26, v23, v26
    v_lshlrev_b32 v26, 4, v26
    s_lshl_b32 s95, s54, 13
    v_lshl_add_u32 v1, v22, 10, v26
    v_add_u32 v1, s95, v1
    v_and_b32 v25, 1, v24
    v_lshlrev_b32 v25, 2, v25
    v_xor_b32 v25, v23, v25
    v_lshlrev_b32 v25, 4, v25
    v_mad_u32_u24 v12, v22, s98, v25
    v_lshl_add_u32 v3, v22, 10, v25
    s_mul_i32 s95, s58, 384
    s_lshl_b32 s96, s58, 7
    s_add_u32 s96, s96, 1024
    s_cmp_eq_u32 s77, 1
    s_cselect_b32 s95, s96, s95
    s_lshl_b32 s96, s54, 5
    s_mul_i32 s97, s96, s98
    s_add_u32 s64, s95, s97
    s_lshl_b32 s98, s98, 3
    s_cmp_eq_u32 s77, 1
    s_mov_b32 s83, 0x18000
    s_cselect_b32 s68, 0x0, s83
    s_cselect_b32 s69, s83, 0x0
    s_mov_b32 s83, 0x8000
    s_cselect_b32 s70, 0x10000, s83
    s_cselect_b32 s71, s83, 0x10000
    s_add_u32 s68, s68, s62
    s_add_u32 s71, s71, s62
    s_add_u32 s69, s69, s61
    s_add_u32 s70, s70, s61
    s_mov_b32 s10, 0x200000
    s_mov_b32 s11, 0x00020000
    s_mov_b32 s96, 0x1c0000
    s_cmp_eq_u32 s77, 1
    s_cselect_b32 s14, 0x180000, s96
    s_mov_b32 s15, 0x00020000
    s_add_u32 s90, s56, 0
    s_and_b32 s90, s90, 3
    s_lshl_b32 s90, s90, 7
    s_add_u32 s90, s90, s63
    s_add_u32 s91, s56, 2
    s_and_b32 s91, s91, 3
    s_lshl_b32 s91, s91, 7
    s_add_u32 s91, s91, s63
    s_add_u32 s91, s91, 0x10000
    s_add_u32 s92, s56, 1
    s_and_b32 s92, s92, 3
    s_lshl_b32 s92, s92, 7
    s_add_u32 s92, s92, s63
    s_add_u32 s93, s56, 3
    s_and_b32 s93, s93, 3
    s_lshl_b32 s93, s93, 7
    s_add_u32 s93, s93, s63
    s_add_u32 s93, s93, 0x10000
    s_waitcnt lgkmcnt(0)
    s_mov_b32 s8, s36
    s_mov_b32 s9, s37
    s_cmp_lg_u32 s2, 0
    s_cbranch_scc1 L_nozero
    s_mov_b32 s24, s52
    s_mov_b32 s25, s53
    s_mov_b32 s26, 0xa00000
    s_mov_b32 s27, 0x00020000
    v_lshlrev_b32 v2, 4, v21
    v_mov_b32 v72, 0
    v_mov_b32 v73, 0
    v_mov_b32 v74, 0
    v_mov_b32 v75, 0
    s_mul_i32 s95, s54, 6144
    buffer_store_dwordx4 v[72:75], v2, s[24:27], s95 offen offset:0 sc1
    buffer_store_dwordx4 v[72:75], v2, s[24:27], s95 offen offset:1024 sc1
    buffer_store_dwordx4 v[72:75], v2, s[24:27], s95 offen offset:2048 sc1
    buffer_store_dwordx4 v[72:75], v2, s[24:27], s95 offen offset:3072 sc1
    s_add_u32 s95, s95, 4096
    buffer_store_dwordx4 v[72:75], v2, s[24:27], s95 offen offset:0 sc1
    buffer_store_dwordx4 v[72:75], v2, s[24:27], s95 offen offset:1024 sc1
L_nozero:
    s_mov_b32 m0, s69
    s_nop 0
    buffer_load_dwordx4 v1, s[8:11], s90 offen lds
    s_add_u32 m0, s69, 0x2000
    s_nop 0
    buffer_load_dwordx4 v1, s[8:11], s91 offen lds
    s_add_u32 m0, s69, 0x4000
    s_nop 0
    buffer_load_dwordx4 v1, s[8:11], s92 offen lds
    s_add_u32 m0, s69, 0x6000
    s_nop 0
    buffer_load_dwordx4 v1, s[8:11], s93 offen lds
    s_cmp_eq_u32 s77, 1
    s_cselect_b32 s12, s38, s44
    s_cselect_b32 s13, s39, s45
    s_mov_b32 m0, s68
    s_mov_b32 s72, s64
    buffer_load_dwordx4 v12, s[12:15], s72 offen lds
    s_add_u32 m0, s68, 1024
    s_add_u32 s72, s72, s98
    buffer_load_dwordx4 v12, s[12:15], s72 offen lds
    s_add_u32 m0, s68, 2048
    s_add_u32 s72, s72, s98
    buffer_load_dwordx4 v12, s[12:15], s72 offen lds
    s_add_u32 m0, s68, 3072
    s_add_u32 s72, s72, s98
    buffer_load_dwordx4 v12, s[12:15], s72 offen lds
    s_lshl_b32 s80, s98, 5
    s_add_u32 s80, s64, s80
    s_mov_b32 s81, s98
    s_mov_b32 s16, s46
    s_mov_b32 s17, s47
    s_mov_b32 s18, 0x1c0000
    s_mov_b32 s19, 0x00020000
    s_mov_b32 s20, s40
    s_mov_b32 s21, s41
    s_mov_b32 s22, 0x80000
    s_mov_b32 s23, 0x00020000
    s_mov_b32 s28, s48
    s_mov_b32 s29, s49
    s_mov_b32 s30, 0x200000
    s_mov_b32 s31, 0x00020000
    s_mov_b32 s32, s50
    s_mov_b32 s33, s51
    s_mov_b32 s34, 0x100
    s_mov_b32 s35, 0x00020000
    s_mov_b32 s24, s52
    s_mov_b32 s25, s53
    s_mov_b32 s26, 0xa00000
    s_mov_b32 s27, 0x00020000
    v_lshlrev_b32 v2, 4, v21
    s_and_b32 s55, s54, 3
    s_lshr_b32 s56, s54, 2
    s_mov_b32 s76, 0x3f803f80
    s_mov_b32 s87, 0x3f317218
    v_lshrrev_b32 v26, 5, v21
    v_bfe_u32 v27, v21, 4, 1
    v_bfe_u32 v28, v21, 2, 2
    v_and_b32 v29, 3, v21
    v_lshrrev_b32 v30, 1, v29
    v_lshl_add_u32 v30, v27, 1, v30
    s_lshl_b32 s95, s56, 2
    v_add_u32 v30, s95, v30
    v_lshrrev_b32 v31, 1, v28
    v_lshlrev_b32 v31, 2, v31
    v_xor_b32 v30, v30, v31
    v_lshlrev_b32 v30, 4, v30
    v_and_b32 v31, 1, v29
    v_lshl_add_u32 v30, v31, 3, v30
    v_lshl_add_u32 v31, v26, 3, v28
    v_lshl_add_u32 v4, v31, 7, v30
    s_add_u32 s95, s55, 0
    s_and_b32 s95, s95, 3
    s_lshl_b32 s95, s95, 13
    v_add_u32 v72, s95, v4
    v_add_u32 v76, 0x10000, v72
    s_add_u32 s95, s55, 1
    s_and_b32 s95, s95, 3
    s_lshl_b32 s95, s95, 13
    v_add_u32 v73, s95, v4
    v_add_u32 v77, 0x10000, v73
    s_add_u32 s95, s55, 2
    s_and_b32 s95, s95, 3
    s_lshl_b32 s95, s95, 13
    v_add_u32 v74, s95, v4
    v_add_u32 v78, 0x10000, v74
    s_add_u32 s95, s55, 3
    s_and_b32 s95, s95, 3
    s_lshl_b32 s95, s95, 13
    v_add_u32 v75, s95, v4
    v_add_u32 v79, 0x10000, v75
    v_and_b32 v27, 31, v21
    v_bfe_u32 v28, v21, 1, 3
    s_lshl_b32 s95, s55, 5
    v_add_u32 v29, s95, v27
    v_lshlrev_b32 v29, 7, v29
    v_add_u32 v30, 0, v26
    v_xor_b32 v30, v30, v28
    v_lshl_add_u32 v8, v30, 4, v29
    v_add_u32 v30, 2, v26
    v_xor_b32 v30, v30, v28
    v_lshl_add_u32 v9, v30, 4, v29
    v_add_u32 v30, 4, v26
    v_xor_b32 v30, v30, v28
    v_lshl_add_u32 v10, v30, 4, v29
    v_add_u32 v30, 6, v26
    v_xor_b32 v30, v30, v28
    v_lshl_add_u32 v11, v30, 4, v29
    v_and_b32 v30, 16, v21
    v_cmp_eq_u32 s[84:85], 0, v30
    s_lshl_b32 s95, s56, 9
    s_add_u32 s101, s95, 0x20400
    s_lshl_b32 s96, s55, 2
    s_add_u32 s95, s101, s96
    v_lshl_add_u32 v30, v21, 4, s95
    v_lshlrev_b32 v31, 2, v21
    v_add_u32 v31, 0x25400, v31
    v_cmp_gt_u32 vcc, 16, v21
    s_nop 1
    v_cndmask_b32 v15, v31, v30, vcc
    v_and_b32 v30, 15, v21
    v_bfe_u32 v31, v21, 4, 1
    v_cmp_eq_u32 vcc, v30, v31
    v_mov_b32 v30, s76
    s_nop 0
    v_cndmask_b32 v16, 0, v30, vcc
    v_mov_b32 v17, v16
    v_mov_b32 v18, v16
    v_mov_b32 v19, v16
    v_mov_b32 v30, 0
    v_mov_b32 v31, 0
    v_mov_b32 v26, 0
    v_mov_b32 v27, 0
    s_lshl_b32 s95, s60, 7
    s_lshl_b32 s96, s56, 15
    s_add_u32 s95, s95, s96
    s_mul_i32 s88, s55, 393216
    s_add_u32 s88, s88, s95
    s_lshl_b32 s82, s55, 16
    s_add_u32 s82, s82, s95
    s_add_u32 s82, s82, 0x180000
    s_lshl_b32 s89, s55, 17
    s_add_u32 s89, s89, s95
    s_lshl_b32 s99, s55, 13
    s_lshl_b32 s96, s56, 12
    s_add_u32 s99, s99, s96
    s_lshr_b32 s92, s59, 1
    s_lshl_b32 s92, s92, 7
    s_lshl_b32 s93, s57, 7
    s_lshl_b32 s95, s59, 1
    s_add_u32 s95, s95, s56
    s_mul_i32 s95, s95, 147456
    s_add_u32 s95, s95, 0x100000
    s_mul_i32 s96, s55, 24576
    s_add_u32 s90, s95, s96
    s_lshl_b32 s96, s55, 12
    s_add_u32 s100, s95, s96
    s_add_u32 s100, s100, 98304
    s_lshl_b32 s96, s55, 13
    s_add_u32 s91, s95, s96
    s_add_u32 s91, s91, 114688
    s_add_u32 s74, s56, 2
    s_and_b32 s74, s74, 3
    s_lshl_b32 s74, s74, 7
    s_add_u32 s74, s74, s63
    s_mov_b32 m0, s70
    s_add_u32 s72, s74, 0x0
    buffer_load_dwordx4 v1, s[8:11], s72 offen lds
    s_add_u32 s74, s56, 4
    s_and_b32 s74, s74, 3
    s_lshl_b32 s74, s74, 7
    s_add_u32 s74, s74, s63
    s_add_u32 m0, s70, 0x2000
    s_add_u32 s73, s74, 0x10000
    buffer_load_dwordx4 v1, s[8:11], s73 offen lds
    s_add_u32 s74, s56, 3
    s_and_b32 s74, s74, 3
    s_lshl_b32 s74, s74, 7
    s_add_u32 s74, s74, s63
    s_add_u32 m0, s70, 0x4000
    s_add_u32 s72, s74, 0x0
    buffer_load_dwordx4 v1, s[8:11], s72 offen lds
    s_add_u32 s74, s56, 5
    s_and_b32 s74, s74, 3
    s_lshl_b32 s74, s74, 7
    s_add_u32 s74, s74, s63
    s_add_u32 m0, s70, 0x6000
    s_add_u32 s73, s74, 0x10000
    buffer_load_dwordx4 v1, s[8:11], s73 offen lds
    s_cmp_eq_u32 s77, 1
    s_cbranch_scc1 L_att
    s_lshl_b32 s97, s57, 2
    s_add_u32 s97, s97, s55
    s_mul_i32 s97, s97, 147456
    s_add_u32 s97, s97, 0x100000
    s_add_u32 s65, s64, 128
    s_add_u32 s66, s64, 256
    s_lshr_b32 s96, s58, 1
    s_lshl_b32 s96, s96, 7
    s_mul_i32 s98, s54, 114688
    s_add_u32 s96, s96, s98
    s_add_u32 s67, s96, 3072
    s_lshl_b32 s98, s58, 11
    s_add_u32 s71, s97, s98
    s_lshl_b32 s98, s56, 10
    s_add_u32 s71, s71, s98
    s_add_u32 s71, s71, 98304
    s_mul_i32 s98, s58, 12288
    s_add_u32 s97, s97, s98
    s_lshl_b32 s98, s56, 11
    s_add_u32 s68, s97, s98
    s_add_u32 s69, s68, 4096
    s_add_u32 s70, s68, 8192
    v_mov_b32 v64, 0
    v_mov_b32 v65, 0
    v_mov_b32 v66, 0
    v_mov_b32 v67, 0
    s_waitcnt vmcnt(4)
    s_barrier
    ds_read_b128 v[128:131], v8 offset:0
    ds_read_b64_tr_b16 v[80:81], v76 offset:32768
    ds_read_b64_tr_b16 v[82:83], v76 offset:33280
    ds_read_b128 v[132:135], v9 offset:0
    ds_read_b64_tr_b16 v[84:85], v76 offset:34816
    ds_read_b64_tr_b16 v[86:87], v76 offset:35328
    ds_read_b64_tr_b16 v[88:89], v76 offset:36864
    ds_read_b64_tr_b16 v[90:91], v76 offset:37376
    ds_read_b128 v[136:139], v10 offset:0
    s_cmp_lg_u32 s2, 0
    s_waitcnt lgkmcnt(0)
    s_cbranch_scc1 L_nozf0
    s_cmp_lg_u32 s54, 0
    s_cbranch_scc1 L_nozf0
    v_mov_b32 v68, 1
    s_mov_b64 exec, 1
    buffer_store_dword v68, off, s[32:35], 0 sc1
    s_mov_b64 exec, -1
L_nozf0:
    v_mfma_f32_32x32x16_bf16 v[96:111], v[80:83], v[128:131], 0
    ds_read_b128 v[140:143], v11 offset:0
    v_mfma_f32_16x16x32_bf16 v[20:23], v[16:19], v[80:83], 0
    ds_read_b64_tr_b16 v[92:93], v76 offset:38912
    ds_read_b64_tr_b16 v[94:95], v76 offset:39424
    s_add_u32 s74, s56, 0
    s_and_b32 s74, s74, 3
    s_lshl_b32 s74, s74, 7
    s_add_u32 s74, s74, s63
    s_add_u32 m0, s61, 0x20000
    s_add_u32 s72, s74, 0x200
    buffer_load_dwordx4 v1, s[8:11], s72 offen lds
    v_mfma_f32_32x32x16_bf16 v[96:111], v[84:87], v[132:135], v[96:111]
    ds_read_b128 v[144:147], v8 offset:16384
    v_mfma_f32_16x16x32_bf16 v[20:23], v[16:19], v[84:87], v[20:23]
    ds_read_b64_tr_b16 v[80:81], v77 offset:32768
    ds_read_b64_tr_b16 v[82:83], v77 offset:33280
    s_add_u32 s74, s56, 2
    s_and_b32 s74, s74, 3
    s_lshl_b32 s74, s74, 7
    s_add_u32 s74, s74, s63
    s_add_u32 m0, s61, 0x22000
    s_add_u32 s73, s74, 0x10200
    buffer_load_dwordx4 v1, s[8:11], s73 offen lds
    v_mfma_f32_32x32x16_bf16 v[96:111], v[88:91], v[136:139], v[96:111]
    ds_read_b128 v[148:151], v9 offset:16384
    v_mfma_f32_16x16x32_bf16 v[20:23], v[16:19], v[88:91], v[20:23]
    ds_read_b64_tr_b16 v[84:85], v77 offset:34816
    ds_read_b64_tr_b16 v[86:87], v77 offset:35328
    s_add_u32 s74, s56, 1
    s_and_b32 s74, s74, 3
    s_lshl_b32 s74, s74, 7
    s_add_u32 s74, s74, s63
    s_add_u32 m0, s61, 0x24000
    s_add_u32 s72, s74, 0x200
    buffer_load_dwordx4 v1, s[8:11], s72 offen lds
    s_waitcnt lgkmcnt(6)
    v_mfma_f32_32x32x16_bf16 v[96:111], v[92:95], v[140:143], v[96:111]
    ds_read_b128 v[152:155], v10 offset:16384
    v_mfma_f32_16x16x32_bf16 v[20:23], v[16:19], v[92:95], v[20:23]
    ds_read_b64_tr_b16 v[88:89], v77 offset:36864
    ds_read_b64_tr_b16 v[90:91], v77 offset:37376
    s_add_u32 s74, s56, 3
    s_and_b32 s74, s74, 3
    s_lshl_b32 s74, s74, 7
    s_add_u32 s74, s74, s63
    s_add_u32 m0, s61, 0x26000
    s_add_u32 s73, s74, 0x10200
    buffer_load_dwordx4 v1, s[8:11], s73 offen lds
    s_waitcnt lgkmcnt(6)
    v_mfma_f32_32x32x16_bf16 v[96:111], v[80:83], v[144:147], v[96:111]
    ds_read_b128 v[156:159], v11 offset:16384
    ds_read_b64_tr_b16 v[92:93], v77 offset:38912
    ds_read_b64_tr_b16 v[94:95], v77 offset:39424
    s_add_u32 m0, s62, 0x10000
    s_add_u32 s72, s64, 0xe0000
    buffer_load_dwordx4 v12, s[12:15], s72 offen lds
    s_waitcnt lgkmcnt(6)
    v_mfma_f32_32x32x16_bf16 v[96:111], v[84:87], v[148:151], v[96:111]
    ds_read_b64_tr_b16 v[80:81], v78 offset:32768
    ds_read_b64_tr_b16 v[82:83], v78 offset:33280
    s_add_u32 m0, s62, 0x10400
    s_add_u32 s73, s64, 0xe7000
    buffer_load_dwordx4 v12, s[12:15], s73 offen lds
    s_waitcnt lgkmcnt(5)
    v_mfma_f32_32x32x16_bf16 v[96:111], v[88:91], v[152:155], v[96:111]
    ds_read_b64_tr_b16 v[84:85], v78 offset:34816
    ds_read_b64_tr_b16 v[86:87], v78 offset:35328
    s_add_u32 m0, s62, 0x10800
    s_add_u32 s72, s64, 0xee000
    buffer_load_dwordx4 v12, s[12:15], s72 offen lds
    s_waitcnt lgkmcnt(4)
    v_mfma_f32_32x32x16_bf16 v[96:111], v[92:95], v[156:159], v[96:111]
    ds_read_b64_tr_b16 v[88:89], v78 offset:36864
    ds_read_b64_tr_b16 v[90:91], v78 offset:37376
    s_add_u32 m0, s62, 0x10c00
    s_add_u32 s73, s64, 0xf5000
    buffer_load_dwordx4 v12, s[12:15], s73 offen lds
    s_cmp_eq_u32 s56, 0
    s_waitcnt lgkmcnt(0)
    s_cbranch_scc0 L_st_22
    v_dot2c_f32_bf16 v64, v128, v128
    v_dot2c_f32_bf16 v65, v129, v129
    v_dot2c_f32_bf16 v66, v130, v130
    v_dot2c_f32_bf16 v67, v131, v131
    v_dot2c_f32_bf16 v64, v132, v132
    v_dot2c_f32_bf16 v65, v133, v133
    v_dot2c_f32_bf16 v66, v134, v134
    v_dot2c_f32_bf16 v67, v135, v135
    v_dot2c_f32_bf16 v64, v136, v136
    v_dot2c_f32_bf16 v65, v137, v137
    v_dot2c_f32_bf16 v66, v138, v138
    v_dot2c_f32_bf16 v67, v139, v139
    v_dot2c_f32_bf16 v64, v140, v140
    v_dot2c_f32_bf16 v65, v141, v141
    v_dot2c_f32_bf16 v66, v142, v142
    v_dot2c_f32_bf16 v67, v143, v143
    v_dot2c_f32_bf16 v64, v144, v144
    v_dot2c_f32_bf16 v65, v145, v145
    v_dot2c_f32_bf16 v66, v146, v146
    v_dot2c_f32_bf16 v67, v147, v147
    v_dot2c_f32_bf16 v64, v148, v148
    v_dot2c_f32_bf16 v65, v149, v149
    v_dot2c_f32_bf16 v66, v150, v150
    v_dot2c_f32_bf16 v67, v151, v151
    v_dot2c_f32_bf16 v64, v152, v152
    v_dot2c_f32_bf16 v65, v153, v153
    v_dot2c_f32_bf16 v66, v154, v154
    v_dot2c_f32_bf16 v67, v155, v155
    v_dot2c_f32_bf16 v64, v156, v156
    v_dot2c_f32_bf16 v65, v157, v157
    v_dot2c_f32_bf16 v66, v158, v158
    v_dot2c_f32_bf16 v67, v159, v159
    s_branch L_ste_23
L_st_22:
    v_dot2c_f32_bf16 v64, s76, v128
    v_dot2c_f32_bf16 v65, s76, v129
    v_dot2c_f32_bf16 v66, s76, v130
    v_dot2c_f32_bf16 v67, s76, v131
    v_dot2c_f32_bf16 v64, s76, v132
    v_dot2c_f32_bf16 v65, s76, v133
    v_dot2c_f32_bf16 v66, s76, v134
    v_dot2c_f32_bf16 v67, s76, v135
    v_dot2c_f32_bf16 v64, s76, v136
    v_dot2c_f32_bf16 v65, s76, v137
    v_dot2c_f32_bf16 v66, s76, v138
    v_dot2c_f32_bf16 v67, s76, v139
    v_dot2c_f32_bf16 v64, s76, v140
    v_dot2c_f32_bf16 v65, s76, v141
    v_dot2c_f32_bf16 v66, s76, v142
    v_dot2c_f32_bf16 v67, s76, v143
    v_dot2c_f32_bf16 v64, s76, v144
    v_dot2c_f32_bf16 v65, s76, v145
    v_dot2c_f32_bf16 v66, s76, v146
    v_dot2c_f32_bf16 v67, s76, v147
    v_dot2c_f32_bf16 v64, s76, v148
    v_dot2c_f32_bf16 v65, s76, v149
    v_dot2c_f32_bf16 v66, s76, v150
    v_dot2c_f32_bf16 v67, s76, v151
    v_dot2c_f32_bf16 v64, s76, v152
    v_dot2c_f32_bf16 v65, s76, v153
    v_dot2c_f32_bf16 v66, s76, v154
    v_dot2c_f32_bf16 v67, s76, v155
    v_dot2c_f32_bf16 v64, s76, v156
    v_dot2c_f32_bf16 v65, s76, v157
    v_dot2c_f32_bf16 v66, s76, v158
    v_dot2c_f32_bf16 v67, s76, v159
L_ste_23:
    s_waitcnt vmcnt(8) lgkmcnt(0)
    s_barrier
    ds_read_b128 v[160:163], v8 offset:32768
    ds_read_b128 v[164:167], v9 offset:32768
    ds_read_b128 v[168:171], v10 offset:32768
    s_waitcnt lgkmcnt(2)
    v_mfma_f32_32x32x16_bf16 v[96:111], v[80:83], v[160:163], v[96:111]
    ds_read_b128 v[172:175], v11 offset:32768
    ds_read_b64_tr_b16 v[92:93], v78 offset:38912
    ds_read_b64_tr_b16 v[94:95], v78 offset:39424
    s_add_u32 s74, s56, 2
    s_and_b32 s74, s74, 3
    s_lshl_b32 s74, s74, 7
    s_add_u32 s74, s74, s63
    s_mov_b32 m0, s61
    s_add_u32 s73, s74, 0x200
    buffer_load_dwordx4 v1, s[8:11], s73 offen lds
    s_waitcnt lgkmcnt(4)
    v_mfma_f32_32x32x16_bf16 v[96:111], v[84:87], v[164:167], v[96:111]
    ds_read_b128 v[176:179], v8 offset:49152
    ds_read_b64_tr_b16 v[80:81], v79 offset:32768
    ds_read_b64_tr_b16 v[82:83], v79 offset:33280
    s_add_u32 s74, s56, 4
    s_and_b32 s74, s74, 3
    s_lshl_b32 s74, s74, 7
    s_add_u32 s74, s74, s63
    s_add_u32 m0, s61, 0x2000
    s_add_u32 s72, s74, 0x10200
    buffer_load_dwordx4 v1, s[8:11], s72 offen lds
    s_waitcnt lgkmcnt(6)
    v_mfma_f32_32x32x16_bf16 v[96:111], v[88:91], v[168:171], v[96:111]
    ds_read_b128 v[180:183], v9 offset:49152
    ds_read_b64_tr_b16 v[84:85], v79 offset:34816
    ds_read_b64_tr_b16 v[86:87], v79 offset:35328
    s_add_u32 s74, s56, 3
    s_and_b32 s74, s74, 3
    s_lshl_b32 s74, s74, 7
    s_add_u32 s74, s74, s63
    s_add_u32 m0, s61, 0x4000
    s_add_u32 s73, s74, 0x200
    buffer_load_dwordx4 v1, s[8:11], s73 offen lds
    s_waitcnt lgkmcnt(6)
    v_mfma_f32_32x32x16_bf16 v[96:111], v[92:95], v[172:175], v[96:111]
    ds_read_b128 v[184:187], v10 offset:49152
    ds_read_b64_tr_b16 v[88:89], v79 offset:36864
    ds_read_b64_tr_b16 v[90:91], v79 offset:37376
    s_add_u32 s74, s56, 5
    s_and_b32 s74, s74, 3
    s_lshl_b32 s74, s74, 7
    s_add_u32 s74, s74, s63
    s_add_u32 m0, s61, 0x6000
    s_add_u32 s72, s74, 0x10200
    buffer_load_dwordx4 v1, s[8:11], s72 offen lds
    s_waitcnt lgkmcnt(6)
    v_mfma_f32_32x32x16_bf16 v[96:111], v[80:83], v[176:179], v[96:111]
    ds_read_b128 v[188:191], v11 offset:49152
    ds_read_b64_tr_b16 v[92:93], v79 offset:38912
    ds_read_b64_tr_b16 v[94:95], v79 offset:39424
    s_waitcnt lgkmcnt(6)
    v_mfma_f32_32x32x16_bf16 v[96:111], v[84:87], v[180:183], v[96:111]
    v_lshrrev_b32 v49, 4, v2
    v_and_b32 v49, 7, v49
    v_lshrrev_b32 v50, 7, v2
    s_and_b32 s95, s57, 7
    s_lshl_b32 s95, s95, 6
    s_lshl_b32 s96, s54, 3
    s_add_u32 s95, s95, s96
    v_add_u32 v49, s95, v49
    s_movk_i32 s96, 3584
    v_mul_u32_u24 v49, s96, v49
    s_mul_i32 s97, s54, 114688
    s_sub_u32 s95, s65, s97
    v_mov_b32 v51, s95
    s_sub_u32 s95, s66, s97
    v_mov_b32 v52, s95
    v_cmp_eq_u32 vcc, 1, v50
    s_nop 1
    v_cndmask_b32 v51, v51, v52, vcc
    s_sub_u32 s95, s67, s97
    v_mov_b32 v52, s95
    v_cmp_eq_u32 vcc, 2, v50
    s_nop 1
    v_cndmask_b32 v51, v51, v52, vcc
    v_add_u32 v48, v49, v51
    s_mov_b32 exec_lo, 0xffffff
    s_mov_b32 exec_hi, 0
    buffer_load_dword v0, v48, s[12:15], 0 offen
    s_mov_b64 exec, -1
    s_waitcnt lgkmcnt(3)
    v_mfma_f32_32x32x16_bf16 v[96:111], v[88:91], v[184:187], v[96:111]
    s_waitcnt lgkmcnt(0)
    v_mfma_f32_32x32x16_bf16 v[96:111], v[92:95], v[188:191], v[96:111]
    s_cmp_eq_u32 s56, 0
    s_cbranch_scc0 L_st_33
    v_dot2c_f32_bf16 v64, v160, v160
    v_dot2c_f32_bf16 v65, v161, v161
    v_dot2c_f32_bf16 v66, v162, v162
    v_dot2c_f32_bf16 v67, v163, v163
    v_dot2c_f32_bf16 v64, v164, v164
    v_dot2c_f32_bf16 v65, v165, v165
    v_dot2c_f32_bf16 v66, v166, v166
    v_dot2c_f32_bf16 v67, v167, v167
    v_dot2c_f32_bf16 v64, v168, v168
    v_dot2c_f32_bf16 v65, v169, v169
    v_dot2c_f32_bf16 v66, v170, v170
    v_dot2c_f32_bf16 v67, v171, v171
    v_dot2c_f32_bf16 v64, v172, v172
    v_dot2c_f32_bf16 v65, v173, v173
    v_dot2c_f32_bf16 v66, v174, v174
    v_dot2c_f32_bf16 v67, v175, v175
    v_dot2c_f32_bf16 v64, v176, v176
    v_dot2c_f32_bf16 v65, v177, v177
    v_dot2c_f32_bf16 v66, v178, v178
    v_dot2c_f32_bf16 v67, v179, v179
    v_dot2c_f32_bf16 v64, v180, v180
    v_dot2c_f32_bf16 v65, v181, v181
    v_dot2c_f32_bf16 v66, v182, v182
    v_dot2c_f32_bf16 v67, v183, v183
    v_dot2c_f32_bf16 v64, v184, v184
    v_dot2c_f32_bf16 v65, v185, v185
    v_dot2c_f32_bf16 v66, v186, v186
    v_dot2c_f32_bf16 v67, v187, v187
    v_dot2c_f32_bf16 v64, v188, v188
    v_dot2c_f32_bf16 v65, v189, v189
    v_dot2c_f32_bf16 v66, v190, v190
    v_dot2c_f32_bf16 v67, v191, v191
    s_branch L_ste_34
L_st_33:
    v_dot2c_f32_bf16 v64, s76, v160
    v_dot2c_f32_bf16 v65, s76, v161
    v_dot2c_f32_bf16 v66, s76, v162
    v_dot2c_f32_bf16 v67, s76, v163
    v_dot2c_f32_bf16 v64, s76, v164
    v_dot2c_f32_bf16 v65, s76, v165
    v_dot2c_f32_bf16 v66, s76, v166
    v_dot2c_f32_bf16 v67, s76, v167
    v_dot2c_f32_bf16 v64, s76, v168
    v_dot2c_f32_bf16 v65, s76, v169
    v_dot2c_f32_bf16 v66, s76, v170
    v_dot2c_f32_bf16 v67, s76, v171
    v_dot2c_f32_bf16 v64, s76, v172
    v_dot2c_f32_bf16 v65, s76, v173
    v_dot2c_f32_bf16 v66, s76, v174
    v_dot2c_f32_bf16 v67, s76, v175
    v_dot2c_f32_bf16 v64, s76, v176
    v_dot2c_f32_bf16 v65, s76, v177
    v_dot2c_f32_bf16 v66, s76, v178
    v_dot2c_f32_bf16 v67, s76, v179
    v_dot2c_f32_bf16 v64, s76, v180
    v_dot2c_f32_bf16 v65, s76, v181
    v_dot2c_f32_bf16 v66, s76, v182
    v_dot2c_f32_bf16 v67, s76, v183
    v_dot2c_f32_bf16 v64, s76, v184
    v_dot2c_f32_bf16 v65, s76, v185
    v_dot2c_f32_bf16 v66, s76, v186
    v_dot2c_f32_bf16 v67, s76, v187
    v_dot2c_f32_bf16 v64, s76, v188
    v_dot2c_f32_bf16 v65, s76, v189
    v_dot2c_f32_bf16 v66, s76, v190
    v_dot2c_f32_bf16 v67, s76, v191
L_ste_34:
    s_waitcnt vmcnt(4) lgkmcnt(0)
    s_barrier
    v_add_u32 v8, 0x20000, v8
    v_add_u32 v9, 0x20000, v9
    v_add_u32 v10, 0x20000, v10
    v_add_u32 v11, 0x20000, v11
    ds_read_b128 v[192:195], v8 offset:0
    ds_read_b64_tr_b16 v[80:81], v76 offset:0
    ds_read_b64_tr_b16 v[82:83], v76 offset:512
    ds_read_b128 v[196:199], v9 offset:0
    ds_read_b64_tr_b16 v[84:85], v76 offset:2048
    ds_read_b64_tr_b16 v[86:87], v76 offset:2560
    ds_read_b64_tr_b16 v[88:89], v76 offset:4096
    ds_read_b64_tr_b16 v[90:91], v76 offset:4608
    ds_read_b128 v[200:203], v10 offset:0
    s_waitcnt lgkmcnt(6)
    v_mfma_f32_32x32x16_bf16 v[96:111], v[80:83], v[192:195], v[96:111]
    ds_read_b128 v[204:207], v11 offset:0
    v_mfma_f32_16x16x32_bf16 v[20:23], v[16:19], v[80:83], v[20:23]
    ds_read_b64_tr_b16 v[92:93], v76 offset:6144
    ds_read_b64_tr_b16 v[94:95], v76 offset:6656
    s_add_u32 m0, s62, 0x18000
    s_add_u32 s73, s65, 0x0
    buffer_load_dwordx4 v12, s[12:15], s73 offen lds
    s_waitcnt lgkmcnt(6)
    v_mfma_f32_32x32x16_bf16 v[96:111], v[84:87], v[196:199], v[96:111]
    ds_read_b128 v[208:211], v8 offset:16384
    v_mfma_f32_16x16x32_bf16 v[20:23], v[16:19], v[84:87], v[20:23]
    ds_read_b64_tr_b16 v[80:81], v77 offset:0
    ds_read_b64_tr_b16 v[82:83], v77 offset:512
    s_waitcnt lgkmcnt(6)
    v_mfma_f32_32x32x16_bf16 v[96:111], v[88:91], v[200:203], v[96:111]
    ds_read_b128 v[212:215], v9 offset:16384
    v_mfma_f32_16x16x32_bf16 v[20:23], v[16:19], v[88:91], v[20:23]
    ds_read_b64_tr_b16 v[84:85], v77 offset:2048
    ds_read_b64_tr_b16 v[86:87], v77 offset:2560
    s_add_u32 m0, s62, 0x18400
    s_add_u32 s72, s65, 0x7000
    buffer_load_dwordx4 v12, s[12:15], s72 offen lds
    s_waitcnt lgkmcnt(6)
    v_mfma_f32_32x32x16_bf16 v[96:111], v[92:95], v[204:207], v[96:111]
    ds_read_b128 v[216:219], v10 offset:16384
    v_mfma_f32_16x16x32_bf16 v[20:23], v[16:19], v[92:95], v[20:23]
    ds_read_b64_tr_b16 v[88:89], v77 offset:4096
    ds_read_b64_tr_b16 v[90:91], v77 offset:4608
    s_waitcnt lgkmcnt(6)
    v_mfma_f32_32x32x16_bf16 v[96:111], v[80:83], v[208:211], v[96:111]
    ds_read_b128 v[220:223], v11 offset:16384
    ds_read_b64_tr_b16 v[92:93], v77 offset:6144
    ds_read_b64_tr_b16 v[94:95], v77 offset:6656
    s_add_u32 m0, s62, 0x18800
    s_add_u32 s73, s65, 0xe000
    buffer_load_dwordx4 v12, s[12:15], s73 offen lds
    s_waitcnt lgkmcnt(6)
    v_mfma_f32_32x32x16_bf16 v[96:111], v[84:87], v[212:215], v[96:111]
    ds_read_b64_tr_b16 v[80:81], v78 offset:0
    ds_read_b64_tr_b16 v[82:83], v78 offset:512
    s_waitcnt lgkmcnt(5)
    v_mfma_f32_32x32x16_bf16 v[96:111], v[88:91], v[216:219], v[96:111]
    ds_read_b64_tr_b16 v[84:85], v78 offset:2048
    ds_read_b64_tr_b16 v[86:87], v78 offset:2560
    s_add_u32 m0, s62, 0x18c00
    s_add_u32 s72, s65, 0x15000
    buffer_load_dwordx4 v12, s[12:15], s72 offen lds
    s_waitcnt lgkmcnt(4)
    v_mfma_f32_32x32x16_bf16 v[96:111], v[92:95], v[220:223], v[96:111]
    ds_read_b64_tr_b16 v[88:89], v78 offset:4096
    ds_read_b64_tr_b16 v[90:91], v78 offset:4608
    s_cmp_eq_u32 s56, 0
    s_waitcnt lgkmcnt(0)
    s_cbranch_scc0 L_st_43
    v_dot2c_f32_bf16 v64, v192, v192
    v_dot2c_f32_bf16 v65, v193, v193
    v_dot2c_f32_bf16 v66, v194, v194
    v_dot2c_f32_bf16 v67, v195, v195
    v_dot2c_f32_bf16 v64, v196, v196
    v_dot2c_f32_bf16 v65, v197, v197
    v_dot2c_f32_bf16 v66, v198, v198
    v_dot2c_f32_bf16 v67, v199, v199
    v_dot2c_f32_bf16 v64, v200, v200
    v_dot2c_f32_bf16 v65, v201, v201
    v_dot2c_f32_bf16 v66, v202, v202
    v_dot2c_f32_bf16 v67, v203, v203
    v_dot2c_f32_bf16 v64, v204, v204
    v_dot2c_f32_bf16 v65, v205, v205
    v_dot2c_f32_bf16 v66, v206, v206
    v_dot2c_f32_bf16 v67, v207, v207
    v_dot2c_f32_bf16 v64, v208, v208
    v_dot2c_f32_bf16 v65, v209, v209
    v_dot2c_f32_bf16 v66, v210, v210
    v_dot2c_f32_bf16 v67, v211, v211
    v_dot2c_f32_bf16 v64, v212, v212
    v_dot2c_f32_bf16 v65, v213, v213
    v_dot2c_f32_bf16 v66, v214, v214
    v_dot2c_f32_bf16 v67, v215, v215
    v_dot2c_f32_bf16 v64, v216, v216
    v_dot2c_f32_bf16 v65, v217, v217
    v_dot2c_f32_bf16 v66, v218, v218
    v_dot2c_f32_bf16 v67, v219, v219
    v_dot2c_f32_bf16 v64, v220, v220
    v_dot2c_f32_bf16 v65, v221, v221
    v_dot2c_f32_bf16 v66, v222, v222
    v_dot2c_f32_bf16 v67, v223, v223
    s_branch L_ste_44
L_st_43:
    v_dot2c_f32_bf16 v64, s76, v192
    v_dot2c_f32_bf16 v65, s76, v193
    v_dot2c_f32_bf16 v66, s76, v194
    v_dot2c_f32_bf16 v67, s76, v195
    v_dot2c_f32_bf16 v64, s76, v196
    v_dot2c_f32_bf16 v65, s76, v197
    v_dot2c_f32_bf16 v66, s76, v198
    v_dot2c_f32_bf16 v67, s76, v199
    v_dot2c_f32_bf16 v64, s76, v200
    v_dot2c_f32_bf16 v65, s76, v201
    v_dot2c_f32_bf16 v66, s76, v202
    v_dot2c_f32_bf16 v67, s76, v203
    v_dot2c_f32_bf16 v64, s76, v204
    v_dot2c_f32_bf16 v65, s76, v205
    v_dot2c_f32_bf16 v66, s76, v206
    v_dot2c_f32_bf16 v67, s76, v207
    v_dot2c_f32_bf16 v64, s76, v208
    v_dot2c_f32_bf16 v65, s76, v209
    v_dot2c_f32_bf16 v66, s76, v210
    v_dot2c_f32_bf16 v67, s76, v211
    v_dot2c_f32_bf16 v64, s76, v212
    v_dot2c_f32_bf16 v65, s76, v213
    v_dot2c_f32_bf16 v66, s76, v214
    v_dot2c_f32_bf16 v67, s76, v215
    v_dot2c_f32_bf16 v64, s76, v216
    v_dot2c_f32_bf16 v65, s76, v217
    v_dot2c_f32_bf16 v66, s76, v218
    v_dot2c_f32_bf16 v67, s76, v219
    v_dot2c_f32_bf16 v64, s76, v220
    v_dot2c_f32_bf16 v65, s76, v221
    v_dot2c_f32_bf16 v66, s76, v222
    v_dot2c_f32_bf16 v67, s76, v223
L_ste_44:
    s_waitcnt vmcnt(4) lgkmcnt(0)
    s_barrier
    v_add_u32 v8, 0xfffe0000, v8
    v_add_u32 v9, 0xfffe0000, v9
    v_add_u32 v10, 0xfffe0000, v10
    v_add_u32 v11, 0xfffe0000, v11
    ds_read_b128 v[224:227], v8 offset:0
    ds_read_b128 v[228:231], v9 offset:0
    ds_read_b128 v[232:235], v10 offset:0
    s_waitcnt lgkmcnt(2)
    v_mfma_f32_32x32x16_bf16 v[96:111], v[80:83], v[224:227], v[96:111]
    ds_read_b128 v[236:239], v11 offset:0
    ds_read_b64_tr_b16 v[92:93], v78 offset:6144
    ds_read_b64_tr_b16 v[94:95], v78 offset:6656
    s_add_u32 m0, s62, 0x8000
    s_add_u32 s72, s65, 0xe0000
    buffer_load_dwordx4 v12, s[12:15], s72 offen lds
    s_waitcnt lgkmcnt(4)
    v_mfma_f32_32x32x16_bf16 v[96:111], v[84:87], v[228:231], v[96:111]
    ds_read_b128 v[240:243], v8 offset:16384
    ds_read_b64_tr_b16 v[80:81], v79 offset:0
    ds_read_b64_tr_b16 v[82:83], v79 offset:512
    s_waitcnt lgkmcnt(6)
    v_mfma_f32_32x32x16_bf16 v[96:111], v[88:91], v[232:235], v[96:111]
    ds_read_b128 v[244:247], v9 offset:16384
    ds_read_b64_tr_b16 v[84:85], v79 offset:2048
    ds_read_b64_tr_b16 v[86:87], v79 offset:2560
    s_add_u32 m0, s62, 0x8400
    s_add_u32 s73, s65, 0xe7000
    buffer_load_dwordx4 v12, s[12:15], s73 offen lds
    s_waitcnt lgkmcnt(6)
    v_mfma_f32_32x32x16_bf16 v[96:111], v[92:95], v[236:239], v[96:111]
    ds_read_b128 v[248:251], v10 offset:16384
    ds_read_b64_tr_b16 v[88:89], v79 offset:4096
    ds_read_b64_tr_b16 v[90:91], v79 offset:4608
    s_waitcnt lgkmcnt(6)
    v_mfma_f32_32x32x16_bf16 v[96:111], v[80:83], v[240:243], v[96:111]
    ds_read_b128 v[252:255], v11 offset:16384
    ds_read_b64_tr_b16 v[92:93], v79 offset:6144
    ds_read_b64_tr_b16 v[94:95], v79 offset:6656
    s_add_u32 m0, s62, 0x8800
    s_add_u32 s72, s65, 0xee000
    buffer_load_dwordx4 v12, s[12:15], s72 offen lds
    s_waitcnt lgkmcnt(6)
    v_mfma_f32_32x32x16_bf16 v[96:111], v[84:87], v[244:247], v[96:111]
    s_waitcnt lgkmcnt(3)
    v_mfma_f32_32x32x16_bf16 v[96:111], v[88:91], v[248:251], v[96:111]
    s_add_u32 m0, s62, 0x8c00
    s_add_u32 s73, s65, 0xf5000
    buffer_load_dwordx4 v12, s[12:15], s73 offen lds
    s_waitcnt lgkmcnt(0)
    v_mfma_f32_32x32x16_bf16 v[96:111], v[92:95], v[252:255], v[96:111]
    s_cmp_eq_u32 s56, 0
    s_cbranch_scc0 L_st_54
    v_dot2c_f32_bf16 v64, v224, v224
    v_dot2c_f32_bf16 v65, v225, v225
    v_dot2c_f32_bf16 v66, v226, v226
    v_dot2c_f32_bf16 v67, v227, v227
    v_dot2c_f32_bf16 v64, v228, v228
    v_dot2c_f32_bf16 v65, v229, v229
    v_dot2c_f32_bf16 v66, v230, v230
    v_dot2c_f32_bf16 v67, v231, v231
    v_dot2c_f32_bf16 v64, v232, v232
    v_dot2c_f32_bf16 v65, v233, v233
    v_dot2c_f32_bf16 v66, v234, v234
    v_dot2c_f32_bf16 v67, v235, v235
    v_dot2c_f32_bf16 v64, v236, v236
    v_dot2c_f32_bf16 v65, v237, v237
    v_dot2c_f32_bf16 v66, v238, v238
    v_dot2c_f32_bf16 v67, v239, v239
    v_dot2c_f32_bf16 v64, v240, v240
    v_dot2c_f32_bf16 v65, v241, v241
    v_dot2c_f32_bf16 v66, v242, v242
    v_dot2c_f32_bf16 v67, v243, v243
    v_dot2c_f32_bf16 v64, v244, v244
    v_dot2c_f32_bf16 v65, v245, v245
    v_dot2c_f32_bf16 v66, v246, v246
    v_dot2c_f32_bf16 v67, v247, v247
    v_dot2c_f32_bf16 v64, v248, v248
    v_dot2c_f32_bf16 v65, v249, v249
    v_dot2c_f32_bf16 v66, v250, v250
    v_dot2c_f32_bf16 v67, v251, v251
    v_dot2c_f32_bf16 v64, v252, v252
    v_dot2c_f32_bf16 v65, v253, v253
    v_dot2c_f32_bf16 v66, v254, v254
    v_dot2c_f32_bf16 v67, v255, v255
    s_branch L_ste_55
L_st_54:
    v_dot2c_f32_bf16 v64, s76, v224
    v_dot2c_f32_bf16 v65, s76, v225
    v_dot2c_f32_bf16 v66, s76, v226
    v_dot2c_f32_bf16 v67, s76, v227
    v_dot2c_f32_bf16 v64, s76, v228
    v_dot2c_f32_bf16 v65, s76, v229
    v_dot2c_f32_bf16 v66, s76, v230
    v_dot2c_f32_bf16 v67, s76, v231
    v_dot2c_f32_bf16 v64, s76, v232
    v_dot2c_f32_bf16 v65, s76, v233
    v_dot2c_f32_bf16 v66, s76, v234
    v_dot2c_f32_bf16 v67, s76, v235
    v_dot2c_f32_bf16 v64, s76, v236
    v_dot2c_f32_bf16 v65, s76, v237
    v_dot2c_f32_bf16 v66, s76, v238
    v_dot2c_f32_bf16 v67, s76, v239
    v_dot2c_f32_bf16 v64, s76, v240
    v_dot2c_f32_bf16 v65, s76, v241
    v_dot2c_f32_bf16 v66, s76, v242
    v_dot2c_f32_bf16 v67, s76, v243
    v_dot2c_f32_bf16 v64, s76, v244
    v_dot2c_f32_bf16 v65, s76, v245
    v_dot2c_f32_bf16 v66, s76, v246
    v_dot2c_f32_bf16 v67, s76, v247
    v_dot2c_f32_bf16 v64, s76, v248
    v_dot2c_f32_bf16 v65, s76, v249
    v_dot2c_f32_bf16 v66, s76, v250
    v_dot2c_f32_bf16 v67, s76, v251
    v_dot2c_f32_bf16 v64, s76, v252
    v_dot2c_f32_bf16 v65, s76, v253
    v_dot2c_f32_bf16 v66, s76, v254
    v_dot2c_f32_bf16 v67, s76, v255
L_ste_55:
    s_nop 0
    v_add_f32 v64, v64, v65
    s_nop 0
    v_add_f32 v66, v66, v67
    v_add_f32 v64, v64, v66
    v_mov_b32 v65, v64
    s_nop 0
    s_nop 0
    v_permlane32_swap_b32 v64, v65
    v_add_f32 v64, v64, v65
    s_lshl_b32 s95, s56, 9
    s_lshl_b32 s96, s55, 7
    s_add_u32 s95, s95, s96
    s_add_u32 s95, s95, 0x20000
    v_lshrrev_b32 v66, 4, v2
    v_and_b32 v66, 31, v66
    v_lshlrev_b32 v66, 2, v66
    v_add_u32 v67, s95, v66
    ds_write_b32 v67, v64
    ds_write_b32 v15, v20
    ds_write_b32 v15, v21 offset:256
    s_waitcnt vmcnt(4) lgkmcnt(0)
    s_barrier
    s_lshl_b32 s96, s55, 7
    s_add_u32 s96, s96, 0x20000
    v_add_u32 v67, s96, v66
    ds_read_b32 v68, v67
    ds_read_b32 v69, v67 offset:512
    ds_read_b64_tr_b16 v[80:81], v76 offset:32768
    ds_read_b64_tr_b16 v[82:83], v76 offset:33280
    ds_read_b64_tr_b16 v[84:85], v76 offset:34816
    ds_read_b64_tr_b16 v[86:87], v76 offset:35328
    ds_read_b64_tr_b16 v[88:89], v76 offset:36864
    ds_read_b64_tr_b16 v[90:91], v76 offset:37376
    v_lshrrev_b32 v9, 7, v2
    v_lshlrev_b32 v8, 3, v2
    v_and_b32 v8, 0x380, v8
    v_mul_u32_u24 v9, 0x30000, v9
    v_add_u32 v8, v8, v9
    s_lshl_b32 s97, s79, 3
    s_add_u32 s97, s97, s54
    s_lshr_b32 s98, s97, 6
    s_and_b32 s97, s97, 63
    s_mul_i32 s52, s98, 384
    s_add_u32 s52, s52, s97
    s_lshl_b32 s52, s52, 10
    s_mul_i32 s53, s98, 64
    s_add_u32 s53, s53, s97
    s_add_u32 s53, s53, 1536
    s_lshl_b32 s53, s53, 10
    s_mul_i32 s78, s98, 128
    s_add_u32 s78, s78, s97
    s_lshl_b32 s78, s78, 10
    s_waitcnt lgkmcnt(4)
    v_mfma_f32_32x32x16_bf16 v[112:127], v[80:83], v[128:131], 0
    v_mfma_f32_16x16x32_bf16 v[20:23], v[16:19], v[80:83], 0
    ds_read_b64_tr_b16 v[92:93], v76 offset:38912
    ds_read_b64_tr_b16 v[94:95], v76 offset:39424
    s_mov_b32 m0, s62
    s_add_u32 s73, s66, 0x0
    buffer_load_dwordx4 v12, s[12:15], s73 offen lds
    s_waitcnt lgkmcnt(4)
    v_mfma_f32_32x32x16_bf16 v[112:127], v[84:87], v[132:135], v[112:127]
    v_mfma_f32_16x16x32_bf16 v[20:23], v[16:19], v[84:87], v[20:23]
    ds_read_b64_tr_b16 v[80:81], v77 offset:32768
    ds_read_b64_tr_b16 v[82:83], v77 offset:33280
    s_add_u32 m0, s62, 0x400
    s_add_u32 s72, s66, 0x7000
    buffer_load_dwordx4 v12, s[12:15], s72 offen lds
    v_mul_f32 v69, 0x3b000000, v69
    v_mul_f32 v68, 0x3b000000, v68
    v_fma_f32 v68, -v69, v69, v68
    s_waitcnt lgkmcnt(4)
    v_mfma_f32_32x32x16_bf16 v[112:127], v[88:91], v[136:139], v[112:127]
    v_mfma_f32_16x16x32_bf16 v[20:23], v[16:19], v[88:91], v[20:23]
    ds_read_b64_tr_b16 v[84:85], v77 offset:34816
    ds_read_b64_tr_b16 v[86:87], v77 offset:35328
    s_add_u32 m0, s62, 0x800
    s_add_u32 s73, s66, 0xe000
    buffer_load_dwordx4 v12, s[12:15], s73 offen lds
    v_max_f32 v68, 0, v68
    v_add_f32 v68, 0x3727c5ac, v68
    v_sqrt_f32 v14, v68
    v_rsq_f32 v68, v68
    v_sub_f32 v69, 0, v69
    s_waitcnt lgkmcnt(4)
    v_mfma_f32_32x32x16_bf16 v[112:127], v[92:95], v[140:143], v[112:127]
    v_mfma_f32_16x16x32_bf16 v[20:23], v[16:19], v[92:95], v[20:23]
    ds_read_b64_tr_b16 v[88:89], v77 offset:36864
    ds_read_b64_tr_b16 v[90:91], v77 offset:37376
    s_add_u32 m0, s62, 0xc00
    s_add_u32 s72, s66, 0x15000
    buffer_load_dwordx4 v12, s[12:15], s72 offen lds
    v_mul_f32 v13, 0xbfb8aa3b, v68
    v_cvt_pk_bf16_f32 v24, v69, v69
    v_and_b32 v70, 0xffff0000, v24
    v_sub_f32 v70, v69, v70
    s_waitcnt lgkmcnt(4)
    v_mfma_f32_32x32x16_bf16 v[112:127], v[80:83], v[144:147], v[112:127]
    ds_read_b64_tr_b16 v[92:93], v77 offset:38912
    ds_read_b64_tr_b16 v[94:95], v77 offset:39424
    s_add_u32 m0, s62, 0x10000
    s_add_u32 s73, s66, 0xe0000
    buffer_load_dwordx4 v12, s[12:15], s73 offen lds
    v_mov_b32 v71, 0
    v_cvt_pk_bf16_f32 v25, v70, v71
    v_and_b32 v68, 0x1f0, v2
    v_add_u32 v68, s101, v68
    ds_read_b128 v[64:67], v68
    s_waitcnt lgkmcnt(5)
    v_mfma_f32_32x32x16_bf16 v[112:127], v[84:87], v[148:151], v[112:127]
    ds_read_b64_tr_b16 v[80:81], v78 offset:32768
    ds_read_b64_tr_b16 v[82:83], v78 offset:33280
    s_add_u32 m0, s62, 0x10400
    s_add_u32 s72, s66, 0xe7000
    buffer_load_dwordx4 v12, s[12:15], s72 offen lds
    v_cmp_gt_u32 vcc, 512, v2
    s_waitcnt lgkmcnt(2)
    v_add_f32 v64, v64, v65
    v_mfma_f32_32x32x16_bf16 v[112:127], v[88:91], v[152:155], v[112:127]
    ds_read_b64_tr_b16 v[84:85], v78 offset:34816
    ds_read_b64_tr_b16 v[86:87], v78 offset:35328
    s_add_u32 m0, s62, 0x10800
    s_add_u32 s73, s66, 0xee000
    buffer_load_dwordx4 v12, s[12:15], s73 offen lds
    v_add_f32 v66, v66, v67
    v_add_f32 v64, v64, v66
    v_cndmask_b32 v64, 0, v64, vcc
    v_cvt_pk_bf16_f32 v65, v64, v64
    v_mfma_f32_32x32x16_bf16 v[112:127], v[92:95], v[156:159], v[112:127]
    ds_read_b64_tr_b16 v[88:89], v78 offset:36864
    ds_read_b64_tr_b16 v[90:91], v78 offset:37376
    s_add_u32 m0, s62, 0x10c00
    s_add_u32 s72, s66, 0xf5000
    buffer_load_dwordx4 v12, s[12:15], s72 offen lds
    v_and_b32 v65, 0xffff0000, v65
    v_sub_f32 v65, v64, v65
    v_cvt_pk_bf16_f32 v28, v64, v65
    v_and_b32 v29, 0xffff, v28
    s_waitcnt lgkmcnt(4)
    v_mfma_f32_32x32x16_bf16 v[112:127], v[80:83], v[160:163], v[112:127]
    ds_read_b64_tr_b16 v[92:93], v78 offset:38912
    ds_read_b64_tr_b16 v[94:95], v78 offset:39424
    s_cmp_lg_u32 s54, 0
    s_cbranch_scc1 L_zfi_83
    buffer_load_dword v0, off, s[32:35], 0 sc1
L_zfi_83:
    v_mfma_f32_32x32x16_bf16 v[96:111], v[28:31], v[24:27], v[96:111]
    s_waitcnt lgkmcnt(4)
    v_mfma_f32_32x32x16_bf16 v[112:127], v[84:87], v[164:167], v[112:127]
    ds_read_b64_tr_b16 v[80:81], v79 offset:32768
    ds_read_b64_tr_b16 v[82:83], v79 offset:33280
    v_lshlrev_b32 v56, 3, v2
    s_lshl_b32 s97, s2, 3
    s_add_u32 s97, s97, s54
    s_mul_i32 s98, s97, 896
    s_mov_b32 m0, 0x25400
    s_lshl_b32 s97, s97, 8
    s_mov_b64 exec, 0x7f
    buffer_load_dword v56, s[16:19], s98 offen lds
    s_mov_b64 exec, 3
    buffer_load_dword v56, s[20:23], s97 offen lds
    s_mov_b64 exec, -1
    s_waitcnt lgkmcnt(4)
    v_mfma_f32_32x32x16_bf16 v[112:127], v[88:91], v[168:171], v[112:127]
    ds_read_b64_tr_b16 v[84:85], v79 offset:34816
    ds_read_b64_tr_b16 v[86:87], v79 offset:35328
    v_mul_f32 v64, v13, v96
    v_mul_f32 v65, v13, v97
    v_exp_f32 v64, v64
    s_waitcnt lgkmcnt(4)
    v_mfma_f32_32x32x16_bf16 v[112:127], v[92:95], v[172:175], v[112:127]
    ds_read_b64_tr_b16 v[88:89], v79 offset:36864
    ds_read_b64_tr_b16 v[90:91], v79 offset:37376
    v_mul_f32 v66, v13, v98
    v_exp_f32 v65, v65
    v_fma_f32 v64, v64, v14, v14
    v_mul_f32 v67, v13, v99
    v_exp_f32 v66, v66
    s_waitcnt lgkmcnt(4)
    v_mfma_f32_32x32x16_bf16 v[112:127], v[80:83], v[176:179], v[112:127]
    ds_read_b64_tr_b16 v[92:93], v79 offset:38912
    ds_read_b64_tr_b16 v[94:95], v79 offset:39424
    s_waitcnt vmcnt(10)
    s_barrier
    v_fma_f32 v65, v65, v14, v14
    v_rcp_f32 v64, v64
    v_mul_f32 v68, v13, v100
    v_exp_f32 v67, v67
    s_waitcnt lgkmcnt(4)
    v_mfma_f32_32x32x16_bf16 v[112:127], v[84:87], v[180:183], v[112:127]
    ds_read_b64_tr_b16 v[80:81], v72 offset:32768
    ds_read_b64_tr_b16 v[82:83], v72 offset:33280
    v_fma_f32 v66, v66, v14, v14
    v_rcp_f32 v65, v65
    v_mul_f32 v64, v96, v64
    v_mul_f32 v69, v13, v101
    s_waitcnt lgkmcnt(4)
    v_mfma_f32_32x32x16_bf16 v[112:127], v[88:91], v[184:187], v[112:127]
    ds_read_b64_tr_b16 v[84:85], v72 offset:34816
    ds_read_b64_tr_b16 v[86:87], v72 offset:35328
    v_exp_f32 v68, v68
    v_fma_f32 v67, v67, v14, v14
    v_rcp_f32 v66, v66
    v_mul_f32 v65, v97, v65
    v_cvt_pk_bf16_f32 v48, v64, v65
    s_waitcnt lgkmcnt(4)
    v_mfma_f32_32x32x16_bf16 v[112:127], v[92:95], v[188:191], v[112:127]
    ds_read_b64_tr_b16 v[88:89], v72 offset:36864
    ds_read_b64_tr_b16 v[90:91], v72 offset:37376
    v_mul_f32 v70, v13, v102
    v_exp_f32 v69, v69
    v_fma_f32 v68, v68, v14, v14
    v_rcp_f32 v67, v67
    s_waitcnt lgkmcnt(4)
    v_mfma_f32_32x32x16_bf16 v[112:127], v[80:83], v[192:195], v[112:127]
    v_mfma_f32_16x16x32_bf16 v[20:23], v[16:19], v[80:83], v[20:23]
    ds_read_b64_tr_b16 v[92:93], v72 offset:38912
    ds_read_b64_tr_b16 v[94:95], v72 offset:39424
    v_mul_f32 v66, v98, v66
    v_mul_f32 v71, v13, v103
    v_exp_f32 v70, v70
    v_fma_f32 v69, v69, v14, v14
    v_rcp_f32 v68, v68
    s_waitcnt lgkmcnt(4)
    v_mfma_f32_32x32x16_bf16 v[112:127], v[84:87], v[196:199], v[112:127]
    v_mfma_f32_16x16x32_bf16 v[20:23], v[16:19], v[84:87], v[20:23]
    ds_read_b64_tr_b16 v[80:81], v73 offset:32768
    ds_read_b64_tr_b16 v[82:83], v73 offset:33280
    v_mul_f32 v67, v99, v67
    v_cvt_pk_bf16_f32 v49, v66, v67
    v_mul_f32 v64, v13, v104
    v_exp_f32 v71, v71
    s_waitcnt lgkmcnt(4)
    v_mfma_f32_32x32x16_bf16 v[112:127], v[88:91], v[200:203], v[112:127]
    v_mfma_f32_16x16x32_bf16 v[20:23], v[16:19], v[88:91], v[20:23]
    ds_read_b64_tr_b16 v[84:85], v73 offset:34816
    ds_read_b64_tr_b16 v[86:87], v73 offset:35328
    v_fma_f32 v70, v70, v14, v14
    v_rcp_f32 v69, v69
    v_mul_f32 v68, v100, v68
    v_mul_f32 v65, v13, v105
    s_waitcnt lgkmcnt(4)
    v_mfma_f32_32x32x16_bf16 v[112:127], v[92:95], v[204:207], v[112:127]
    v_mfma_f32_16x16x32_bf16 v[20:23], v[16:19], v[92:95], v[20:23]
    ds_read_b64_tr_b16 v[88:89], v73 offset:36864
    ds_read_b64_tr_b16 v[90:91], v73 offset:37376
    v_exp_f32 v64, v64
    v_fma_f32 v71, v71, v14, v14
    v_rcp_f32 v70, v70
    v_mul_f32 v69, v101, v69
    v_cvt_pk_bf16_f32 v50, v68, v69
    s_waitcnt lgkmcnt(4)
    v_mfma_f32_32x32x16_bf16 v[112:127], v[80:83], v[208:211], v[112:127]
    ds_read_b64_tr_b16 v[92:93], v73 offset:38912
    ds_read_b64_tr_b16 v[94:95], v73 offset:39424
    v_mul_f32 v66, v13, v106
    v_exp_f32 v65, v65
    v_fma_f32 v64, v64, v14, v14
    v_rcp_f32 v71, v71
    s_waitcnt lgkmcnt(4)
    v_mfma_f32_32x32x16_bf16 v[112:127], v[84:87], v[212:215], v[112:127]
    ds_read_b64_tr_b16 v[80:81], v74 offset:32768
    ds_read_b64_tr_b16 v[82:83], v74 offset:33280
    v_mul_f32 v70, v102, v70
    v_mul_f32 v67, v13, v107
    v_exp_f32 v66, v66
    v_fma_f32 v65, v65, v14, v14
    v_rcp_f32 v64, v64
    s_waitcnt lgkmcnt(4)
    v_mfma_f32_32x32x16_bf16 v[112:127], v[88:91], v[216:219], v[112:127]
    ds_read_b64_tr_b16 v[84:85], v74 offset:34816
    ds_read_b64_tr_b16 v[86:87], v74 offset:35328
    v_mul_f32 v71, v103, v71
    v_cvt_pk_bf16_f32 v51, v70, v71
    buffer_store_dwordx4 v[48:51], v2, s[24:27], s68 offen offset:0 sc1
    v_mul_f32 v68, v13, v108
    s_waitcnt lgkmcnt(4)
    v_mfma_f32_32x32x16_bf16 v[112:127], v[92:95], v[220:223], v[112:127]
    ds_read_b64_tr_b16 v[88:89], v74 offset:36864
    ds_read_b64_tr_b16 v[90:91], v74 offset:37376
    v_exp_f32 v67, v67
    v_fma_f32 v66, v66, v14, v14
    v_rcp_f32 v65, v65
    v_mul_f32 v64, v104, v64
    v_mul_f32 v69, v13, v109
    s_waitcnt lgkmcnt(4)
    v_mfma_f32_32x32x16_bf16 v[112:127], v[80:83], v[224:227], v[112:127]
    ds_read_b64_tr_b16 v[92:93], v74 offset:38912
    ds_read_b64_tr_b16 v[94:95], v74 offset:39424
    v_exp_f32 v68, v68
    v_fma_f32 v67, v67, v14, v14
    v_rcp_f32 v66, v66
    v_mul_f32 v65, v105, v65
    s_waitcnt lgkmcnt(4)
    v_mfma_f32_32x32x16_bf16 v[112:127], v[84:87], v[228:231], v[112:127]
    ds_read_b64_tr_b16 v[80:81], v75 offset:32768
    ds_read_b64_tr_b16 v[82:83], v75 offset:33280
    v_cvt_pk_bf16_f32 v52, v64, v65
    v_mul_f32 v70, v13, v110
    v_exp_f32 v69, v69
    v_fma_f32 v68, v68, v14, v14
    s_waitcnt lgkmcnt(4)
    v_mfma_f32_32x32x16_bf16 v[112:127], v[88:91], v[232:235], v[112:127]
    ds_read_b64_tr_b16 v[84:85], v75 offset:34816
    ds_read_b64_tr_b16 v[86:87], v75 offset:35328
    s_cmp_lg_u32 s54, 0
    s_waitcnt lgkmcnt(0)
    s_cbranch_scc1 L_zf_f_ok
    s_waitcnt vmcnt(3)
    v_readfirstlane_b32 s83, v0
    s_nop 0
    s_cmp_eq_u32 s83, 1
    s_cbranch_scc1 L_zf_f_ok
    s_mov_b32 s86, 0
    s_mov_b32 s75, 0
L_zf_f:
    buffer_load_dword v0, off, s[32:35], s75 sc1
    s_add_u32 s86, s86, 1
    s_waitcnt vmcnt(0)
    v_readfirstlane_b32 s83, v0
    s_cmp_gt_u32 s86, 0x10000
    s_cbranch_scc1 L_zf_f_to
    s_cmp_lg_u32 s83, 1
    s_cbranch_scc1 L_zf_f
L_zf_f_to:
L_zf_f_ok:
    v_rcp_f32 v67, v67
    v_mul_f32 v66, v106, v66
    v_mul_f32 v71, v13, v111
    v_exp_f32 v70, v70
    v_fma_f32 v69, v69, v14, v14
    v_mfma_f32_32x32x16_bf16 v[112:127], v[92:95], v[236:239], v[112:127]
    ds_read_b64_tr_b16 v[88:89], v75 offset:36864
    ds_read_b64_tr_b16 v[90:91], v75 offset:37376
    ds_write_b32 v15, v20
    ds_write_b32 v15, v21 offset:256
    v_rcp_f32 v68, v68
    v_mul_f32 v67, v107, v67
    v_cvt_pk_bf16_f32 v53, v66, v67
    v_exp_f32 v71, v71
    v_mfma_f32_32x32x16_bf16 v[112:127], v[80:83], v[240:243], v[112:127]
    ds_read_b64_tr_b16 v[92:93], v75 offset:38912
    ds_read_b64_tr_b16 v[94:95], v75 offset:39424
    s_waitcnt vmcnt(7)
    s_waitcnt lgkmcnt(2)
    s_barrier
    s_add_u32 m0, s62, 0x18000
    s_add_u32 s72, s67, 0x0
    buffer_load_dwordx4 v12, s[12:15], s72 offen lds
    v_fma_f32 v70, v70, v14, v14
    v_rcp_f32 v69, v69
    v_mul_f32 v68, v108, v68
    v_fma_f32 v71, v71, v14, v14
    v_rcp_f32 v70, v70
    v_mfma_f32_32x32x16_bf16 v[112:127], v[84:87], v[244:247], v[112:127]
    ds_read_b64_tr_b16 v[80:81], v72 offset:0
    ds_read_b64_tr_b16 v[82:83], v72 offset:512
    s_add_u32 m0, s62, 0x18400
    s_add_u32 s73, s67, 0x7000
    buffer_load_dwordx4 v12, s[12:15], s73 offen lds
    v_mul_f32 v69, v109, v69
    v_cvt_pk_bf16_f32 v54, v68, v69
    v_rcp_f32 v71, v71
    v_mul_f32 v70, v110, v70
    v_mfma_f32_32x32x16_bf16 v[112:127], v[88:91], v[248:251], v[112:127]
    ds_read_b64_tr_b16 v[84:85], v72 offset:2048
    ds_read_b64_tr_b16 v[86:87], v72 offset:2560
    s_add_u32 m0, s62, 0x18800
    s_add_u32 s72, s67, 0xe000
    buffer_load_dwordx4 v12, s[12:15], s72 offen lds
    v_mul_f32 v71, v111, v71
    v_cvt_pk_bf16_f32 v55, v70, v71
    buffer_store_dwordx4 v[52:55], v2, s[24:27], s68 offen offset:1024 sc1
    s_waitcnt lgkmcnt(4)
    v_mfma_f32_32x32x16_bf16 v[112:127], v[92:95], v[252:255], v[112:127]
    ds_read_b64_tr_b16 v[88:89], v72 offset:4096
    ds_read_b64_tr_b16 v[90:91], v72 offset:4608
    s_add_u32 m0, s62, 0x18c00
    s_add_u32 s73, s67, 0x15000
    buffer_load_dwordx4 v12, s[12:15], s73 offen lds
    s_mov_b32 m0, 0x25400
    s_add_u32 s97, s52, 0
    s_mov_b64 exec, 0xffff
    buffer_load_dword v8, s[16:19], s97 offen lds
    s_mov_b64 exec, -1
    s_waitcnt lgkmcnt(4)
    v_mfma_f32_32x32x16_bf16 v[96:111], v[80:83], v[128:131], 0
    v_mfma_f32_16x16x32_bf16 v[20:23], v[16:19], v[80:83], 0
    ds_read_b64_tr_b16 v[92:93], v72 offset:6144
    ds_read_b64_tr_b16 v[94:95], v72 offset:6656
    v_and_b32 v68, 0x1f0, v2
    v_add_u32 v68, s101, v68
    ds_read_b128 v[64:67], v68
    v_cmp_gt_u32 vcc, 512, v2
    s_waitcnt lgkmcnt(5)
    v_mfma_f32_32x32x16_bf16 v[96:111], v[84:87], v[132:135], v[96:111]
    v_mfma_f32_16x16x32_bf16 v[20:23], v[16:19], v[84:87], v[20:23]
    ds_read_b64_tr_b16 v[80:81], v73 offset:0
    ds_read_b64_tr_b16 v[82:83], v73 offset:512
    s_waitcnt lgkmcnt(5)
    v_mfma_f32_32x32x16_bf16 v[96:111], v[88:91], v[136:139], v[96:111]
    v_mfma_f32_16x16x32_bf16 v[20:23], v[16:19], v[88:91], v[20:23]
    ds_read_b64_tr_b16 v[84:85], v73 offset:2048
    ds_read_b64_tr_b16 v[86:87], v73 offset:2560
    s_waitcnt lgkmcnt(4)
    v_add_f32 v64, v64, v65
    v_add_f32 v66, v66, v67
    v_mfma_f32_32x32x16_bf16 v[96:111], v[92:95], v[140:143], v[96:111]
    v_mfma_f32_16x16x32_bf16 v[20:23], v[16:19], v[92:95], v[20:23]
    ds_read_b64_tr_b16 v[88:89], v73 offset:4096
    ds_read_b64_tr_b16 v[90:91], v73 offset:4608
    v_add_f32 v64, v64, v66
    v_cndmask_b32 v64, 0, v64, vcc
    v_cvt_pk_bf16_f32 v65, v64, v64
    v_and_b32 v65, 0xffff0000, v65
    v_sub_f32 v65, v64, v65
    s_waitcnt lgkmcnt(4)
    v_mfma_f32_32x32x16_bf16 v[96:111], v[80:83], v[144:147], v[96:111]
    ds_read_b64_tr_b16 v[92:93], v73 offset:6144
    ds_read_b64_tr_b16 v[94:95], v73 offset:6656
    v_cvt_pk_bf16_f32 v28, v64, v65
    v_and_b32 v29, 0xffff, v28
    s_waitcnt lgkmcnt(4)
    v_mfma_f32_32x32x16_bf16 v[96:111], v[84:87], v[148:151], v[96:111]
    ds_read_b64_tr_b16 v[80:81], v74 offset:0
    ds_read_b64_tr_b16 v[82:83], v74 offset:512
    v_mfma_f32_32x32x16_bf16 v[112:127], v[28:31], v[24:27], v[112:127]
    s_waitcnt lgkmcnt(4)
    v_mfma_f32_32x32x16_bf16 v[96:111], v[88:91], v[152:155], v[96:111]
    ds_read_b64_tr_b16 v[84:85], v74 offset:2048
    ds_read_b64_tr_b16 v[86:87], v74 offset:2560
    s_mov_b32 m0, 0x25400
    s_add_u32 s97, s52, 65536
    s_mov_b64 exec, 0xffff
    buffer_load_dword v8, s[16:19], s97 offen lds
    s_mov_b64 exec, -1
    s_waitcnt lgkmcnt(4)
    v_mfma_f32_32x32x16_bf16 v[96:111], v[92:95], v[156:159], v[96:111]
    ds_read_b64_tr_b16 v[88:89], v74 offset:4096
    ds_read_b64_tr_b16 v[90:91], v74 offset:4608
    v_mul_f32 v64, v13, v112
    v_mul_f32 v65, v13, v113
    v_exp_f32 v64, v64
    v_mul_f32 v66, v13, v114
    v_exp_f32 v65, v65
    s_waitcnt lgkmcnt(4)
    v_mfma_f32_32x32x16_bf16 v[96:111], v[80:83], v[160:163], v[96:111]
    ds_read_b64_tr_b16 v[92:93], v74 offset:6144
    ds_read_b64_tr_b16 v[94:95], v74 offset:6656
    v_fma_f32 v64, v64, v14, v14
    v_mul_f32 v67, v13, v115
    v_exp_f32 v66, v66
    v_fma_f32 v65, v65, v14, v14
    s_waitcnt lgkmcnt(4)
    v_mfma_f32_32x32x16_bf16 v[96:111], v[84:87], v[164:167], v[96:111]
    ds_read_b64_tr_b16 v[80:81], v75 offset:0
    ds_read_b64_tr_b16 v[82:83], v75 offset:512
    v_rcp_f32 v64, v64
    v_mul_f32 v68, v13, v116
    v_exp_f32 v67, v67
    v_fma_f32 v66, v66, v14, v14
    v_rcp_f32 v65, v65
    s_waitcnt lgkmcnt(4)
    v_mfma_f32_32x32x16_bf16 v[96:111], v[88:91], v[168:171], v[96:111]
    ds_read_b64_tr_b16 v[84:85], v75 offset:2048
    ds_read_b64_tr_b16 v[86:87], v75 offset:2560
    v_mul_f32 v64, v112, v64
    v_mul_f32 v69, v13, v117
    v_exp_f32 v68, v68
    v_fma_f32 v67, v67, v14, v14
    v_rcp_f32 v66, v66
    s_waitcnt lgkmcnt(4)
    v_mfma_f32_32x32x16_bf16 v[96:111], v[92:95], v[172:175], v[96:111]
    ds_read_b64_tr_b16 v[88:89], v75 offset:4096
    ds_read_b64_tr_b16 v[90:91], v75 offset:4608
    v_mul_f32 v65, v113, v65
    v_cvt_pk_bf16_f32 v48, v64, v65
    v_mul_f32 v70, v13, v118
    v_exp_f32 v69, v69
    s_waitcnt lgkmcnt(4)
    v_mfma_f32_32x32x16_bf16 v[96:111], v[80:83], v[176:179], v[96:111]
    ds_read_b64_tr_b16 v[92:93], v75 offset:6144
    ds_read_b64_tr_b16 v[94:95], v75 offset:6656
    s_waitcnt vmcnt(3)
    s_barrier
    s_cmp_lg_u32 s54, 0
    s_waitcnt lgkmcnt(0)
    s_cbranch_scc1 L_sigA1
    s_add_u32 s75, s93, 1024
    v_mov_b32 v10, 1
    s_mov_b64 exec, 1
    buffer_atomic_add v10, off, s[24:27], s75
    s_mov_b64 exec, -1
L_sigA1:
    v_fma_f32 v68, v68, v14, v14
    v_rcp_f32 v67, v67
    v_mul_f32 v66, v114, v66
    v_mul_f32 v71, v13, v119
    v_exp_f32 v70, v70
    v_mfma_f32_32x32x16_bf16 v[96:111], v[84:87], v[180:183], v[96:111]
    ds_read_b64_tr_b16 v[80:81], v76 offset:0
    ds_read_b64_tr_b16 v[82:83], v76 offset:512
    s_add_u32 m0, s62, 0x8000
    s_add_u32 s73, s67, 0xe0000
    buffer_load_dwordx4 v12, s[12:15], s73 offen lds
    v_fma_f32 v69, v69, v14, v14
    v_rcp_f32 v68, v68
    v_mul_f32 v67, v115, v67
    v_cvt_pk_bf16_f32 v49, v66, v67
    v_mfma_f32_32x32x16_bf16 v[96:111], v[88:91], v[184:187], v[96:111]
    ds_read_b64_tr_b16 v[84:85], v76 offset:2048
    ds_read_b64_tr_b16 v[86:87], v76 offset:2560
    s_add_u32 m0, s62, 0x8400
    s_add_u32 s72, s67, 0xe7000
    buffer_load_dwordx4 v12, s[12:15], s72 offen lds
    v_mul_f32 v64, v13, v120
    v_exp_f32 v71, v71
    v_fma_f32 v70, v70, v14, v14
    v_rcp_f32 v69, v69
    v_mul_f32 v68, v116, v68
    v_mfma_f32_32x32x16_bf16 v[96:111], v[92:95], v[188:191], v[96:111]
    ds_read_b64_tr_b16 v[88:89], v76 offset:4096
    ds_read_b64_tr_b16 v[90:91], v76 offset:4608
    s_add_u32 m0, s62, 0x8800
    s_add_u32 s73, s67, 0xee000
    buffer_load_dwordx4 v12, s[12:15], s73 offen lds
    v_mul_f32 v65, v13, v121
    v_exp_f32 v64, v64
    v_fma_f32 v71, v71, v14, v14
    v_rcp_f32 v70, v70
    s_waitcnt lgkmcnt(4)
    v_mfma_f32_32x32x16_bf16 v[96:111], v[80:83], v[192:195], v[96:111]
    v_mfma_f32_16x16x32_bf16 v[20:23], v[16:19], v[80:83], v[20:23]
    ds_read_b64_tr_b16 v[92:93], v76 offset:6144
    ds_read_b64_tr_b16 v[94:95], v76 offset:6656
    s_add_u32 m0, s62, 0x8c00
    s_add_u32 s72, s67, 0xf5000
    buffer_load_dwordx4 v12, s[12:15], s72 offen lds
    v_mul_f32 v69, v117, v69
    v_cvt_pk_bf16_f32 v50, v68, v69
    v_mul_f32 v66, v13, v122
    v_exp_f32 v65, v65
    v_fma_f32 v64, v64, v14, v14
    s_waitcnt lgkmcnt(4)
    v_mfma_f32_32x32x16_bf16 v[96:111], v[84:87], v[196:199], v[96:111]
    v_mfma_f32_16x16x32_bf16 v[20:23], v[16:19], v[84:87], v[20:23]
    ds_read_b64_tr_b16 v[80:81], v77 offset:0
    ds_read_b64_tr_b16 v[82:83], v77 offset:512
    v_rcp_f32 v71, v71
    v_mul_f32 v70, v118, v70
    v_mul_f32 v67, v13, v123
    v_exp_f32 v66, v66
    s_waitcnt lgkmcnt(4)
    v_mfma_f32_32x32x16_bf16 v[96:111], v[88:91], v[200:203], v[96:111]
    v_mfma_f32_16x16x32_bf16 v[20:23], v[16:19], v[88:91], v[20:23]
    ds_read_b64_tr_b16 v[84:85], v77 offset:2048
    ds_read_b64_tr_b16 v[86:87], v77 offset:2560
    s_mov_b32 m0, 0x25400
    s_add_u32 s97, s52, 131072
    s_mov_b64 exec, 0xffff
    buffer_load_dword v8, s[16:19], s97 offen lds
    s_mov_b64 exec, -1
    v_fma_f32 v65, v65, v14, v14
    v_rcp_f32 v64, v64
    v_mul_f32 v71, v119, v71
    v_cvt_pk_bf16_f32 v51, v70, v71
    buffer_store_dwordx4 v[48:51], v2, s[24:27], s69 offen offset:0 sc1
    s_waitcnt lgkmcnt(4)
    v_mfma_f32_32x32x16_bf16 v[96:111], v[92:95], v[204:207], v[96:111]
    v_mfma_f32_16x16x32_bf16 v[20:23], v[16:19], v[92:95], v[20:23]
    ds_read_b64_tr_b16 v[88:89], v77 offset:4096
    ds_read_b64_tr_b16 v[90:91], v77 offset:4608
    v_mul_f32 v68, v13, v124
    v_exp_f32 v67, v67
    v_fma_f32 v66, v66, v14, v14
    v_rcp_f32 v65, v65
    v_mul_f32 v64, v120, v64
    s_waitcnt lgkmcnt(4)
    v_mfma_f32_32x32x16_bf16 v[96:111], v[80:83], v[208:211], v[96:111]
    ds_read_b64_tr_b16 v[92:93], v77 offset:6144
    ds_read_b64_tr_b16 v[94:95], v77 offset:6656
    v_mul_f32 v69, v13, v125
    v_exp_f32 v68, v68
    v_fma_f32 v67, v67, v14, v14
    v_rcp_f32 v66, v66
    s_waitcnt lgkmcnt(4)
    v_mfma_f32_32x32x16_bf16 v[96:111], v[84:87], v[212:215], v[96:111]
    ds_read_b64_tr_b16 v[80:81], v78 offset:0
    ds_read_b64_tr_b16 v[82:83], v78 offset:512
    v_mul_f32 v65, v121, v65
    v_cvt_pk_bf16_f32 v52, v64, v65
    v_mul_f32 v70, v13, v126
    v_exp_f32 v69, v69
    v_fma_f32 v68, v68, v14, v14
    s_waitcnt lgkmcnt(4)
    v_mfma_f32_32x32x16_bf16 v[96:111], v[88:91], v[216:219], v[96:111]
    ds_read_b64_tr_b16 v[84:85], v78 offset:2048
    ds_read_b64_tr_b16 v[86:87], v78 offset:2560
    v_rcp_f32 v67, v67
    v_mul_f32 v66, v122, v66
    v_mul_f32 v71, v13, v127
    v_exp_f32 v70, v70
    s_waitcnt lgkmcnt(4)
    v_mfma_f32_32x32x16_bf16 v[96:111], v[92:95], v[220:223], v[96:111]
    ds_read_b64_tr_b16 v[88:89], v78 offset:4096
    ds_read_b64_tr_b16 v[90:91], v78 offset:4608
    v_fma_f32 v69, v69, v14, v14
    v_rcp_f32 v68, v68
    v_mul_f32 v67, v123, v67
    v_cvt_pk_bf16_f32 v53, v66, v67
    v_exp_f32 v71, v71
    s_waitcnt lgkmcnt(4)
    v_mfma_f32_32x32x16_bf16 v[96:111], v[80:83], v[224:227], v[96:111]
    ds_read_b64_tr_b16 v[92:93], v78 offset:6144
    ds_read_b64_tr_b16 v[94:95], v78 offset:6656
    s_mov_b32 m0, 0x25400
    s_add_u32 s97, s53, 0
    s_mov_b64 exec, 0xff
    buffer_load_dword v8, s[16:19], s97 offen lds
    s_mov_b64 exec, -1
    v_fma_f32 v70, v70, v14, v14
    v_rcp_f32 v69, v69
    v_mul_f32 v68, v124, v68
    v_fma_f32 v71, v71, v14, v14
    s_waitcnt lgkmcnt(4)
    v_mfma_f32_32x32x16_bf16 v[96:111], v[84:87], v[228:231], v[96:111]
    ds_read_b64_tr_b16 v[80:81], v79 offset:0
    ds_read_b64_tr_b16 v[82:83], v79 offset:512
    v_rcp_f32 v70, v70
    v_mul_f32 v69, v125, v69
    v_cvt_pk_bf16_f32 v54, v68, v69
    v_rcp_f32 v71, v71
    v_mul_f32 v70, v126, v70
    s_waitcnt lgkmcnt(4)
    v_mfma_f32_32x32x16_bf16 v[96:111], v[88:91], v[232:235], v[96:111]
    ds_read_b64_tr_b16 v[84:85], v79 offset:2048
    ds_read_b64_tr_b16 v[86:87], v79 offset:2560
    v_mul_f32 v71, v127, v71
    v_cvt_pk_bf16_f32 v55, v70, v71
    buffer_store_dwordx4 v[52:55], v2, s[24:27], s69 offen offset:1024 sc1
    s_waitcnt lgkmcnt(4)
    v_mfma_f32_32x32x16_bf16 v[96:111], v[92:95], v[236:239], v[96:111]
    ds_read_b64_tr_b16 v[88:89], v79 offset:4096
    ds_read_b64_tr_b16 v[90:91], v79 offset:4608
    ds_write_b32 v15, v20
    ds_write_b32 v15, v21 offset:256
    s_waitcnt lgkmcnt(6)
    v_mfma_f32_32x32x16_bf16 v[96:111], v[80:83], v[240:243], v[96:111]
    ds_read_b64_tr_b16 v[92:93], v79 offset:6144
    ds_read_b64_tr_b16 v[94:95], v79 offset:6656
    s_waitcnt vmcnt(4)
    s_waitcnt lgkmcnt(2)
    s_barrier
    s_mov_b32 m0, s99
    s_add_u32 s73, s88, 0x0
    buffer_load_dwordx4 v3, s[16:19], s73 offen lds
    v_mfma_f32_32x32x16_bf16 v[96:111], v[84:87], v[244:247], v[96:111]
    s_add_u32 m0, s99, 0x400
    s_add_u32 s72, s88, 0x2000
    buffer_load_dwordx4 v3, s[16:19], s72 offen lds
    v_mfma_f32_32x32x16_bf16 v[96:111], v[88:91], v[248:251], v[96:111]
    s_add_u32 m0, s99, 0x800
    s_add_u32 s73, s88, 0x4000
    buffer_load_dwordx4 v3, s[16:19], s73 offen lds
    s_waitcnt lgkmcnt(0)
    v_mfma_f32_32x32x16_bf16 v[96:111], v[92:95], v[252:255], v[96:111]
    s_add_u32 m0, s99, 0xc00
    s_add_u32 s72, s88, 0x6000
    buffer_load_dwordx4 v3, s[16:19], s72 offen lds
    s_and_b32 s95, s58, 1
    s_xor_b32 s95, s95, s56
    s_lshl_b32 s95, s95, 6
    s_cmp_eq_u32 s56, 0
    s_mov_b32 s96, 0x8000
    s_cselect_b32 s96, 0x18000, s96
    v_xor_b32 v72, s95, v72
    v_add_u32 v72, s96, v72
    v_xor_b32 v73, s95, v73
    v_add_u32 v73, s96, v73
    v_xor_b32 v74, s95, v74
    v_add_u32 v74, s96, v74
    v_xor_b32 v75, s95, v75
    v_add_u32 v75, s96, v75
    s_lshl_b32 s95, s55, 12
    s_lshl_b32 s96, s56, 11
    s_add_u32 s95, s95, s96
    s_add_u32 s95, s95, 0x21000
    v_add_u32 v7, s95, v2
    ds_read_b64_tr_b16 v[80:81], v72 offset:0
    ds_read_b64_tr_b16 v[82:83], v72 offset:512
    ds_read_b64_tr_b16 v[84:85], v72 offset:2048
    ds_read_b64_tr_b16 v[86:87], v72 offset:2560
    ds_read_b64_tr_b16 v[88:89], v72 offset:4096
    ds_read_b64_tr_b16 v[90:91], v72 offset:4608
    s_cmp_eq_u32 s56, 0
    s_waitcnt lgkmcnt(0)
    s_cbranch_scc0 L_h1
    v_mfma_f32_32x32x16_bf16 v[112:127], v[80:83], v[128:131], 0
    ds_read_b64_tr_b16 v[92:93], v72 offset:6144
    ds_read_b64_tr_b16 v[94:95], v72 offset:6656
    v_mfma_f32_16x16x32_bf16 v[20:23], v[16:19], v[80:83], 0
    v_and_b32 v68, 0x1f0, v2
    v_add_u32 v68, s101, v68
    ds_read_b128 v[64:67], v68
    v_cmp_gt_u32 vcc, 512, v2
    v_mfma_f32_32x32x16_bf16 v[112:127], v[84:87], v[132:135], v[112:127]
    ds_read_b64_tr_b16 v[80:81], v73 offset:0
    ds_read_b64_tr_b16 v[82:83], v73 offset:512
    v_mfma_f32_16x16x32_bf16 v[20:23], v[16:19], v[84:87], v[20:23]
    s_mov_b32 m0, 0x25400
    s_add_u32 s97, s78, 0
    s_mov_b64 exec, 0xff
    buffer_load_dword v8, s[20:23], s97 offen lds
    s_mov_b64 exec, -1
    s_waitcnt lgkmcnt(2)
    v_add_f32 v64, v64, v65
    v_add_f32 v66, v66, v67
    v_add_f32 v64, v64, v66
    v_cndmask_b32 v64, 0, v64, vcc
    v_cvt_pk_bf16_f32 v65, v64, v64
    v_and_b32 v65, 0xffff0000, v65
    v_sub_f32 v65, v64, v65
    v_mfma_f32_32x32x16_bf16 v[112:127], v[88:91], v[136:139], v[112:127]
    ds_read_b64_tr_b16 v[84:85], v73 offset:2048
    ds_read_b64_tr_b16 v[86:87], v73 offset:2560
    v_mfma_f32_16x16x32_bf16 v[20:23], v[16:19], v[88:91], v[20:23]
    v_cvt_pk_bf16_f32 v28, v64, v65
    v_and_b32 v29, 0xffff, v28
    s_nop 0
    s_nop 0
    v_mfma_f32_32x32x16_bf16 v[96:111], v[28:31], v[24:27], v[96:111]
    v_mfma_f32_32x32x16_bf16 v[112:127], v[92:95], v[140:143], v[112:127]
    ds_read_b64_tr_b16 v[88:89], v73 offset:4096
    ds_read_b64_tr_b16 v[90:91], v73 offset:4608
    v_mfma_f32_16x16x32_bf16 v[20:23], v[16:19], v[92:95], v[20:23]
    s_nop 7
    v_mul_f32 v64, v13, v96
    v_mul_f32 v65, v13, v97
    v_exp_f32 v64, v64
    s_waitcnt lgkmcnt(4)
    v_mfma_f32_32x32x16_bf16 v[112:127], v[80:83], v[144:147], v[112:127]
    ds_read_b64_tr_b16 v[92:93], v73 offset:6144
    ds_read_b64_tr_b16 v[94:95], v73 offset:6656
    v_mul_f32 v66, v13, v98
    v_exp_f32 v65, v65
    v_fma_f32 v64, v64, v14, v14
    v_mul_f32 v67, v13, v99
    v_exp_f32 v66, v66
    v_fma_f32 v65, v65, v14, v14
    v_rcp_f32 v64, v64
    v_mul_f32 v68, v13, v100
    s_waitcnt lgkmcnt(4)
    v_mfma_f32_32x32x16_bf16 v[112:127], v[84:87], v[148:151], v[112:127]
    ds_read_b64_tr_b16 v[80:81], v74 offset:0
    ds_read_b64_tr_b16 v[82:83], v74 offset:512
    s_cmp_lg_u32 s54, 0
    s_cbranch_scc1 L_p0i_119
    s_add_u32 s75, s92, 1024
    buffer_load_dword v0, off, s[24:27], s75 sc1
L_p0i_119:
    v_exp_f32 v67, v67
    v_fma_f32 v66, v66, v14, v14
    v_rcp_f32 v65, v65
    v_mul_f32 v64, v96, v64
    v_mul_f32 v69, v13, v101
    v_exp_f32 v68, v68
    v_fma_f32 v67, v67, v14, v14
    s_waitcnt lgkmcnt(4)
    v_mfma_f32_32x32x16_bf16 v[112:127], v[88:91], v[152:155], v[112:127]
    ds_read_b64_tr_b16 v[84:85], v74 offset:2048
    ds_read_b64_tr_b16 v[86:87], v74 offset:2560
    ds_write_b32 v15, v20 offset:2048
    ds_write_b32 v15, v21 offset:2304
    v_rcp_f32 v66, v66
    v_mul_f32 v65, v97, v65
    v_cvt_pk_bf16_f32 v48, v64, v65
    v_mul_f32 v70, v13, v102
    v_exp_f32 v69, v69
    v_fma_f32 v68, v68, v14, v14
    v_rcp_f32 v67, v67
    s_waitcnt lgkmcnt(6)
    v_mfma_f32_32x32x16_bf16 v[112:127], v[92:95], v[156:159], v[112:127]
    ds_read_b64_tr_b16 v[88:89], v74 offset:4096
    ds_read_b64_tr_b16 v[90:91], v74 offset:4608
    v_mul_f32 v66, v98, v66
    v_mul_f32 v71, v13, v103
    v_exp_f32 v70, v70
    v_fma_f32 v69, v69, v14, v14
    v_rcp_f32 v68, v68
    v_mul_f32 v67, v99, v67
    v_cvt_pk_bf16_f32 v49, v66, v67
    s_waitcnt lgkmcnt(6)
    v_mfma_f32_32x32x16_bf16 v[112:127], v[80:83], v[160:163], v[112:127]
    ds_read_b64_tr_b16 v[92:93], v74 offset:6144
    ds_read_b64_tr_b16 v[94:95], v74 offset:6656
    v_mul_f32 v64, v13, v104
    v_exp_f32 v71, v71
    v_fma_f32 v70, v70, v14, v14
    v_rcp_f32 v69, v69
    v_mul_f32 v68, v100, v68
    v_mul_f32 v65, v13, v105
    v_exp_f32 v64, v64
    v_fma_f32 v71, v71, v14, v14
    s_waitcnt lgkmcnt(6)
    v_mfma_f32_32x32x16_bf16 v[112:127], v[84:87], v[164:167], v[112:127]
    ds_read_b64_tr_b16 v[80:81], v75 offset:0
    ds_read_b64_tr_b16 v[82:83], v75 offset:512
    s_waitcnt vmcnt(5)
    s_waitcnt lgkmcnt(6)
    s_barrier
    s_cmp_lg_u32 s54, 0
    s_waitcnt lgkmcnt(0)
    s_cbranch_scc1 L_sigA2a
    s_add_u32 s75, s93, 3072
    v_mov_b32 v10, 1
    s_mov_b64 exec, 1
    buffer_atomic_add v10, off, s[24:27], s75
    s_mov_b64 exec, -1
L_sigA2a:
    v_rcp_f32 v70, v70
    v_mul_f32 v69, v101, v69
    v_cvt_pk_bf16_f32 v50, v68, v69
    v_mul_f32 v66, v13, v106
    v_exp_f32 v65, v65
    v_fma_f32 v64, v64, v14, v14
    v_rcp_f32 v71, v71
    v_mfma_f32_32x32x16_bf16 v[112:127], v[88:91], v[168:171], v[112:127]
    ds_read_b64_tr_b16 v[84:85], v75 offset:2048
    ds_read_b64_tr_b16 v[86:87], v75 offset:2560
    s_add_u32 m0, s99, 0x10000
    s_add_u32 s72, s88, 0x30000
    buffer_load_dwordx4 v3, s[16:19], s72 offen lds
    v_mul_f32 v70, v102, v70
    v_mul_f32 v67, v13, v107
    v_exp_f32 v66, v66
    v_fma_f32 v65, v65, v14, v14
    v_rcp_f32 v64, v64
    v_mul_f32 v71, v103, v71
    v_cvt_pk_bf16_f32 v51, v70, v71
    v_mfma_f32_32x32x16_bf16 v[112:127], v[92:95], v[172:175], v[112:127]
    ds_read_b64_tr_b16 v[88:89], v75 offset:4096
    ds_read_b64_tr_b16 v[90:91], v75 offset:4608
    v_and_b32 v36, 0x1f0, v2
    v_add_u32 v36, s101, v36
    ds_read_b128 v[32:35], v36 offset:2048
    v_lshrrev_b32 v37, 9, v2
    s_add_u32 m0, s99, 0x10400
    s_add_u32 s73, s88, 0x32000
    buffer_load_dwordx4 v3, s[16:19], s73 offen lds
    buffer_store_dwordx4 v[48:51], v2, s[24:27], s70 offen offset:0 sc1
    v_mul_f32 v68, v13, v108
    v_exp_f32 v67, v67
    v_fma_f32 v66, v66, v14, v14
    v_rcp_f32 v65, v65
    v_mul_f32 v64, v104, v64
    v_mul_f32 v69, v13, v109
    v_mfma_f32_32x32x16_bf16 v[112:127], v[80:83], v[176:179], v[112:127]
    ds_read_b64_tr_b16 v[92:93], v75 offset:6144
    ds_read_b64_tr_b16 v[94:95], v75 offset:6656
    s_add_u32 m0, s99, 0x10800
    s_add_u32 s72, s88, 0x34000
    buffer_load_dwordx4 v3, s[16:19], s72 offen lds
    v_exp_f32 v68, v68
    v_fma_f32 v67, v67, v14, v14
    v_rcp_f32 v66, v66
    v_mul_f32 v65, v105, v65
    v_cvt_pk_bf16_f32 v52, v64, v65
    v_mul_f32 v70, v13, v110
    v_exp_f32 v69, v69
    v_fma_f32 v68, v68, v14, v14
    s_waitcnt lgkmcnt(5)
    v_mfma_f32_32x32x16_bf16 v[112:127], v[84:87], v[180:183], v[112:127]
    s_waitcnt lgkmcnt(2)
    v_add_f32 v32, v32, v33
    v_add_f32 v34, v34, v35
    v_sub_u32 v37, 1, v37
    s_add_u32 m0, s99, 0x10c00
    s_add_u32 s73, s88, 0x36000
    buffer_load_dwordx4 v3, s[16:19], s73 offen lds
    v_rcp_f32 v67, v67
    v_mul_f32 v66, v106, v66
    v_mul_f32 v71, v13, v111
    v_exp_f32 v70, v70
    v_fma_f32 v69, v69, v14, v14
    v_rcp_f32 v68, v68
    v_mul_f32 v67, v107, v67
    v_mfma_f32_32x32x16_bf16 v[112:127], v[88:91], v[184:187], v[112:127]
    v_add_f32 v32, v32, v34
    v_cvt_f32_u32 v37, v37
    v_mul_f32 v32, v32, v37
    v_cvt_pk_bf16_f32 v33, v32, v32
    s_mov_b32 m0, 0x25400
    s_add_u32 s97, s78, 65536
    s_mov_b64 exec, 0xff
    buffer_load_dword v8, s[20:23], s97 offen lds
    s_mov_b64 exec, -1
    v_cvt_pk_bf16_f32 v53, v66, v67
    v_exp_f32 v71, v71
    v_fma_f32 v70, v70, v14, v14
    v_rcp_f32 v69, v69
    v_mul_f32 v68, v108, v68
    v_fma_f32 v71, v71, v14, v14
    v_rcp_f32 v70, v70
    s_waitcnt lgkmcnt(0)
    v_mfma_f32_32x32x16_bf16 v[112:127], v[92:95], v[188:191], v[112:127]
    v_and_b32 v33, 0xffff0000, v33
    v_sub_f32 v33, v32, v33
    v_cvt_pk_bf16_f32 v28, v32, v33
    v_and_b32 v29, 0xffff, v28
    v_mul_f32 v69, v109, v69
    v_cvt_pk_bf16_f32 v54, v68, v69
    v_rcp_f32 v71, v71
    v_mul_f32 v70, v110, v70
    v_mul_f32 v71, v111, v71
    v_cvt_pk_bf16_f32 v55, v70, v71
    buffer_store_dwordx4 v[52:55], v2, s[24:27], s70 offen offset:1024 sc1
    v_mfma_f32_32x32x16_bf16 v[112:127], v[28:31], v[24:27], v[112:127]
    s_nop 11
    ds_write_b128 v7, v[120:123]
    ds_write_b128 v7, v[124:127] offset:1024
    v_xor_b32 v7, 0x800, v7
    s_cmp_lg_u32 s54, 0
    s_waitcnt lgkmcnt(0)
    s_cbranch_scc1 L_pa1fa_ok
    s_waitcnt vmcnt(7)
    v_readfirstlane_b32 s83, v0
    s_nop 0
    s_cmp_eq_u32 s83, 8
    s_cbranch_scc1 L_pa1fa_ok
    s_mov_b32 s86, 0
    s_add_u32 s75, s92, 1024
L_pa1fa:
    buffer_load_dword v0, off, s[24:27], s75 sc1
    s_add_u32 s86, s86, 1
    s_waitcnt vmcnt(0)
    v_readfirstlane_b32 s83, v0
    s_cmp_gt_u32 s86, 0x10000
    s_cbranch_scc1 L_pa1fa_to
    s_cmp_lg_u32 s83, 8
    s_cbranch_scc1 L_pa1fa
L_pa1fa_to:
L_pa1fa_ok:
    s_waitcnt lgkmcnt(0)
    s_barrier
    ds_read_b128 v[80:83], v7
    ds_read_b128 v[84:87], v7 offset:1024
    s_add_u32 m0, s99, 0x18000
    s_add_u32 s72, s88, 0x10000
    buffer_load_dwordx4 v3, s[16:19], s72 offen lds
    s_add_u32 m0, s99, 0x18400
    s_add_u32 s73, s88, 0x12000
    buffer_load_dwordx4 v3, s[16:19], s73 offen lds
    s_add_u32 m0, s99, 0x18800
    s_add_u32 s72, s88, 0x14000
    buffer_load_dwordx4 v3, s[16:19], s72 offen lds
    s_add_u32 m0, s99, 0x18c00
    s_add_u32 s73, s88, 0x16000
    buffer_load_dwordx4 v3, s[16:19], s73 offen lds
    s_waitcnt lgkmcnt(1)
    v_add_f32 v112, v112, v80
    v_add_f32 v113, v113, v81
    v_add_f32 v114, v114, v82
    v_add_f32 v115, v115, v83
    s_waitcnt lgkmcnt(0)
    v_add_f32 v116, v116, v84
    v_add_f32 v117, v117, v85
    v_add_f32 v118, v118, v86
    v_add_f32 v119, v119, v87
    v_mul_f32 v64, v13, v112
    v_mul_f32 v65, v13, v113
    v_exp_f32 v64, v64
    v_mul_f32 v66, v13, v114
    v_exp_f32 v65, v65
    v_fma_f32 v64, v64, v14, v14
    v_mul_f32 v67, v13, v115
    v_exp_f32 v66, v66
    v_fma_f32 v65, v65, v14, v14
    v_rcp_f32 v64, v64
    v_mul_f32 v68, v13, v116
    v_exp_f32 v67, v67
    v_fma_f32 v66, v66, v14, v14
    v_rcp_f32 v65, v65
    v_mul_f32 v64, v112, v64
    v_mul_f32 v69, v13, v117
    v_exp_f32 v68, v68
    v_fma_f32 v67, v67, v14, v14
    v_rcp_f32 v66, v66
    v_mul_f32 v65, v113, v65
    v_cvt_pk_bf16_f32 v56, v64, v65
    v_mul_f32 v70, v13, v118
    v_exp_f32 v69, v69
    v_fma_f32 v68, v68, v14, v14
    v_rcp_f32 v67, v67
    v_mul_f32 v66, v114, v66
    v_mul_f32 v71, v13, v119
    v_exp_f32 v70, v70
    v_fma_f32 v69, v69, v14, v14
    v_rcp_f32 v68, v68
    v_mul_f32 v67, v115, v67
    v_cvt_pk_bf16_f32 v57, v66, v67
    v_exp_f32 v71, v71
    v_fma_f32 v70, v70, v14, v14
    v_rcp_f32 v69, v69
    v_mul_f32 v68, v116, v68
    v_fma_f32 v71, v71, v14, v14
    v_rcp_f32 v70, v70
    v_mul_f32 v69, v117, v69
    v_cvt_pk_bf16_f32 v58, v68, v69
    v_rcp_f32 v71, v71
    v_mul_f32 v70, v118, v70
    v_mul_f32 v71, v119, v71
    v_cvt_pk_bf16_f32 v59, v70, v71
    buffer_store_dwordx4 v[56:59], v2, s[24:27], s71 offen sc1
    s_add_u32 s74, s90, 0
    buffer_load_dwordx4 v[128:131], v2, s[24:27], s74 offen offset:0 sc1
    buffer_load_dwordx4 v[132:135], v2, s[24:27], s74 offen offset:1024 sc1
    buffer_load_dwordx4 v[136:139], v2, s[24:27], s74 offen offset:2048 sc1
    buffer_load_dwordx4 v[140:143], v2, s[24:27], s74 offen offset:3072 sc1
    s_add_u32 s74, s90, 12288
    buffer_load_dwordx4 v[144:147], v2, s[24:27], s74 offen offset:0 sc1
    buffer_load_dwordx4 v[148:151], v2, s[24:27], s74 offen offset:1024 sc1
    buffer_load_dwordx4 v[152:155], v2, s[24:27], s74 offen offset:2048 sc1
    buffer_load_dwordx4 v[156:159], v2, s[24:27], s74 offen offset:3072 sc1
    s_cmp_lg_u32 s54, 0
    s_cbranch_scc1 L_p0i_128
    s_add_u32 s75, s92, 3072
    buffer_load_dword v0, off, s[24:27], s75 sc1
L_p0i_128:
    s_branch L_s2
L_h1:
    v_mfma_f32_32x32x16_bf16 v[112:127], v[80:83], v[192:195], 0
    ds_read_b64_tr_b16 v[92:93], v72 offset:6144
    ds_read_b64_tr_b16 v[94:95], v72 offset:6656
    v_mfma_f32_16x16x32_bf16 v[20:23], v[16:19], v[80:83], 0
    v_and_b32 v68, 0x1f0, v2
    v_add_u32 v68, s101, v68
    ds_read_b128 v[64:67], v68
    v_cmp_gt_u32 vcc, 512, v2
    v_mfma_f32_32x32x16_bf16 v[112:127], v[84:87], v[196:199], v[112:127]
    ds_read_b64_tr_b16 v[80:81], v73 offset:0
    ds_read_b64_tr_b16 v[82:83], v73 offset:512
    v_mfma_f32_16x16x32_bf16 v[20:23], v[16:19], v[84:87], v[20:23]
    s_mov_b32 m0, 0x25400
    s_add_u32 s97, s78, 0
    s_mov_b64 exec, 0xff
    buffer_load_dword v8, s[20:23], s97 offen lds
    s_mov_b64 exec, -1
    s_waitcnt lgkmcnt(2)
    v_add_f32 v64, v64, v65
    v_add_f32 v66, v66, v67
    v_add_f32 v64, v64, v66
    v_cndmask_b32 v64, 0, v64, vcc
    v_cvt_pk_bf16_f32 v65, v64, v64
    v_and_b32 v65, 0xffff0000, v65
    v_sub_f32 v65, v64, v65
    v_mfma_f32_32x32x16_bf16 v[112:127], v[88:91], v[200:203], v[112:127]
    ds_read_b64_tr_b16 v[84:85], v73 offset:2048
    ds_read_b64_tr_b16 v[86:87], v73 offset:2560
    v_mfma_f32_16x16x32_bf16 v[20:23], v[16:19], v[88:91], v[20:23]
    v_cvt_pk_bf16_f32 v28, v64, v65
    v_and_b32 v29, 0xffff, v28
    s_nop 0
    s_nop 0
    v_mfma_f32_32x32x16_bf16 v[96:111], v[28:31], v[24:27], v[96:111]
    v_mfma_f32_32x32x16_bf16 v[112:127], v[92:95], v[204:207], v[112:127]
    ds_read_b64_tr_b16 v[88:89], v73 offset:4096
    ds_read_b64_tr_b16 v[90:91], v73 offset:4608
    v_mfma_f32_16x16x32_bf16 v[20:23], v[16:19], v[92:95], v[20:23]
    s_nop 7
    v_mul_f32 v64, v13, v96
    v_mul_f32 v65, v13, v97
    v_exp_f32 v64, v64
    s_waitcnt lgkmcnt(4)
    v_mfma_f32_32x32x16_bf16 v[112:127], v[80:83], v[208:211], v[112:127]
    ds_read_b64_tr_b16 v[92:93], v73 offset:6144
    ds_read_b64_tr_b16 v[94:95], v73 offset:6656
    v_mul_f32 v66, v13, v98
    v_exp_f32 v65, v65
    v_fma_f32 v64, v64, v14, v14
    v_mul_f32 v67, v13, v99
    v_exp_f32 v66, v66
    v_fma_f32 v65, v65, v14, v14
    v_rcp_f32 v64, v64
    v_mul_f32 v68, v13, v100
    s_waitcnt lgkmcnt(4)
    v_mfma_f32_32x32x16_bf16 v[112:127], v[84:87], v[212:215], v[112:127]
    ds_read_b64_tr_b16 v[80:81], v74 offset:0
    ds_read_b64_tr_b16 v[82:83], v74 offset:512
    s_cmp_lg_u32 s54, 0
    s_cbranch_scc1 L_p0i_137
    s_add_u32 s75, s92, 1024
    buffer_load_dword v0, off, s[24:27], s75 sc1
L_p0i_137:
    v_exp_f32 v67, v67
    v_fma_f32 v66, v66, v14, v14
    v_rcp_f32 v65, v65
    v_mul_f32 v64, v96, v64
    v_mul_f32 v69, v13, v101
    v_exp_f32 v68, v68
    v_fma_f32 v67, v67, v14, v14
    s_waitcnt lgkmcnt(4)
    v_mfma_f32_32x32x16_bf16 v[112:127], v[88:91], v[216:219], v[112:127]
    ds_read_b64_tr_b16 v[84:85], v74 offset:2048
    ds_read_b64_tr_b16 v[86:87], v74 offset:2560
    ds_write_b32 v15, v20 offset:2048
    ds_write_b32 v15, v21 offset:2304
    v_rcp_f32 v66, v66
    v_mul_f32 v65, v97, v65
    v_cvt_pk_bf16_f32 v48, v64, v65
    v_mul_f32 v70, v13, v102
    v_exp_f32 v69, v69
    v_fma_f32 v68, v68, v14, v14
    v_rcp_f32 v67, v67
    s_waitcnt lgkmcnt(6)
    v_mfma_f32_32x32x16_bf16 v[112:127], v[92:95], v[220:223], v[112:127]
    ds_read_b64_tr_b16 v[88:89], v74 offset:4096
    ds_read_b64_tr_b16 v[90:91], v74 offset:4608
    v_mul_f32 v66, v98, v66
    v_mul_f32 v71, v13, v103
    v_exp_f32 v70, v70
    v_fma_f32 v69, v69, v14, v14
    v_rcp_f32 v68, v68
    v_mul_f32 v67, v99, v67
    v_cvt_pk_bf16_f32 v49, v66, v67
    s_waitcnt lgkmcnt(6)
    v_mfma_f32_32x32x16_bf16 v[112:127], v[80:83], v[224:227], v[112:127]
    ds_read_b64_tr_b16 v[92:93], v74 offset:6144
    ds_read_b64_tr_b16 v[94:95], v74 offset:6656
    v_mul_f32 v64, v13, v104
    v_exp_f32 v71, v71
    v_fma_f32 v70, v70, v14, v14
    v_rcp_f32 v69, v69
    v_mul_f32 v68, v100, v68
    v_mul_f32 v65, v13, v105
    v_exp_f32 v64, v64
    v_fma_f32 v71, v71, v14, v14
    s_waitcnt lgkmcnt(6)
    v_mfma_f32_32x32x16_bf16 v[112:127], v[84:87], v[228:231], v[112:127]
    ds_read_b64_tr_b16 v[80:81], v75 offset:0
    ds_read_b64_tr_b16 v[82:83], v75 offset:512
    s_waitcnt vmcnt(5)
    s_waitcnt lgkmcnt(6)
    s_barrier
    s_cmp_lg_u32 s54, 0
    s_waitcnt lgkmcnt(0)
    s_cbranch_scc1 L_sigA2b
    s_add_u32 s75, s93, 3072
    v_mov_b32 v10, 1
    s_mov_b64 exec, 1
    buffer_atomic_add v10, off, s[24:27], s75
    s_mov_b64 exec, -1
L_sigA2b:
    v_rcp_f32 v70, v70
    v_mul_f32 v69, v101, v69
    v_cvt_pk_bf16_f32 v50, v68, v69
    v_mul_f32 v66, v13, v106
    v_exp_f32 v65, v65
    v_fma_f32 v64, v64, v14, v14
    v_rcp_f32 v71, v71
    v_mfma_f32_32x32x16_bf16 v[112:127], v[88:91], v[232:235], v[112:127]
    ds_read_b64_tr_b16 v[84:85], v75 offset:2048
    ds_read_b64_tr_b16 v[86:87], v75 offset:2560
    s_add_u32 m0, s99, 0x10000
    s_add_u32 s72, s88, 0x30000
    buffer_load_dwordx4 v3, s[16:19], s72 offen lds
    v_mul_f32 v70, v102, v70
    v_mul_f32 v67, v13, v107
    v_exp_f32 v66, v66
    v_fma_f32 v65, v65, v14, v14
    v_rcp_f32 v64, v64
    v_mul_f32 v71, v103, v71
    v_cvt_pk_bf16_f32 v51, v70, v71
    v_mfma_f32_32x32x16_bf16 v[112:127], v[92:95], v[236:239], v[112:127]
    ds_read_b64_tr_b16 v[88:89], v75 offset:4096
    ds_read_b64_tr_b16 v[90:91], v75 offset:4608
    v_and_b32 v36, 0x1f0, v2
    v_add_u32 v36, s101, v36
    ds_read_b128 v[32:35], v36 offset:2048
    v_lshrrev_b32 v37, 9, v2
    s_add_u32 m0, s99, 0x10400
    s_add_u32 s73, s88, 0x32000
    buffer_load_dwordx4 v3, s[16:19], s73 offen lds
    buffer_store_dwordx4 v[48:51], v2, s[24:27], s70 offen offset:0 sc1
    v_mul_f32 v68, v13, v108
    v_exp_f32 v67, v67
    v_fma_f32 v66, v66, v14, v14
    v_rcp_f32 v65, v65
    v_mul_f32 v64, v104, v64
    v_mul_f32 v69, v13, v109
    v_mfma_f32_32x32x16_bf16 v[112:127], v[80:83], v[240:243], v[112:127]
    ds_read_b64_tr_b16 v[92:93], v75 offset:6144
    ds_read_b64_tr_b16 v[94:95], v75 offset:6656
    s_add_u32 m0, s99, 0x10800
    s_add_u32 s72, s88, 0x34000
    buffer_load_dwordx4 v3, s[16:19], s72 offen lds
    v_exp_f32 v68, v68
    v_fma_f32 v67, v67, v14, v14
    v_rcp_f32 v66, v66
    v_mul_f32 v65, v105, v65
    v_cvt_pk_bf16_f32 v52, v64, v65
    v_mul_f32 v70, v13, v110
    v_exp_f32 v69, v69
    v_fma_f32 v68, v68, v14, v14
    s_waitcnt lgkmcnt(5)
    v_mfma_f32_32x32x16_bf16 v[112:127], v[84:87], v[244:247], v[112:127]
    s_waitcnt lgkmcnt(2)
    v_add_f32 v32, v32, v33
    v_add_f32 v34, v34, v35
    v_sub_u32 v37, 1, v37
    s_add_u32 m0, s99, 0x10c00
    s_add_u32 s73, s88, 0x36000
    buffer_load_dwordx4 v3, s[16:19], s73 offen lds
    v_rcp_f32 v67, v67
    v_mul_f32 v66, v106, v66
    v_mul_f32 v71, v13, v111
    v_exp_f32 v70, v70
    v_fma_f32 v69, v69, v14, v14
    v_rcp_f32 v68, v68
    v_mul_f32 v67, v107, v67
    v_mfma_f32_32x32x16_bf16 v[112:127], v[88:91], v[248:251], v[112:127]
    v_add_f32 v32, v32, v34
    v_cvt_f32_u32 v37, v37
    v_mul_f32 v32, v32, v37
    v_cvt_pk_bf16_f32 v33, v32, v32
    s_mov_b32 m0, 0x25400
    s_add_u32 s97, s78, 65536
    s_mov_b64 exec, 0xff
    buffer_load_dword v8, s[20:23], s97 offen lds
    s_mov_b64 exec, -1
    v_cvt_pk_bf16_f32 v53, v66, v67
    v_exp_f32 v71, v71
    v_fma_f32 v70, v70, v14, v14
    v_rcp_f32 v69, v69
    v_mul_f32 v68, v108, v68
    v_fma_f32 v71, v71, v14, v14
    v_rcp_f32 v70, v70
    s_waitcnt lgkmcnt(0)
    v_mfma_f32_32x32x16_bf16 v[112:127], v[92:95], v[252:255], v[112:127]
    v_and_b32 v33, 0xffff0000, v33
    v_sub_f32 v33, v32, v33
    v_cvt_pk_bf16_f32 v28, v32, v33
    v_and_b32 v29, 0xffff, v28
    v_mul_f32 v69, v109, v69
    v_cvt_pk_bf16_f32 v54, v68, v69
    v_rcp_f32 v71, v71
    v_mul_f32 v70, v110, v70
    v_mul_f32 v71, v111, v71
    v_cvt_pk_bf16_f32 v55, v70, v71
    buffer_store_dwordx4 v[52:55], v2, s[24:27], s70 offen offset:1024 sc1
    v_mfma_f32_32x32x16_bf16 v[112:127], v[28:31], v[24:27], v[112:127]
    s_nop 11
    ds_write_b128 v7, v[112:115]
    ds_write_b128 v7, v[116:119] offset:1024
    v_xor_b32 v7, 0x800, v7
    s_cmp_lg_u32 s54, 0
    s_waitcnt lgkmcnt(0)
    s_cbranch_scc1 L_pa1fb_ok
    s_waitcnt vmcnt(7)
    v_readfirstlane_b32 s83, v0
    s_nop 0
    s_cmp_eq_u32 s83, 8
    s_cbranch_scc1 L_pa1fb_ok
    s_mov_b32 s86, 0
    s_add_u32 s75, s92, 1024
L_pa1fb:
    buffer_load_dword v0, off, s[24:27], s75 sc1
    s_add_u32 s86, s86, 1
    s_waitcnt vmcnt(0)
    v_readfirstlane_b32 s83, v0
    s_cmp_gt_u32 s86, 0x10000
    s_cbranch_scc1 L_pa1fb_to
    s_cmp_lg_u32 s83, 8
    s_cbranch_scc1 L_pa1fb
L_pa1fb_to:
L_pa1fb_ok:
    s_waitcnt lgkmcnt(0)
    s_barrier
    ds_read_b128 v[80:83], v7
    ds_read_b128 v[84:87], v7 offset:1024
    s_add_u32 m0, s99, 0x18000
    s_add_u32 s72, s88, 0x10000
    buffer_load_dwordx4 v3, s[16:19], s72 offen lds
    s_add_u32 m0, s99, 0x18400
    s_add_u32 s73, s88, 0x12000
    buffer_load_dwordx4 v3, s[16:19], s73 offen lds
    s_add_u32 m0, s99, 0x18800
    s_add_u32 s72, s88, 0x14000
    buffer_load_dwordx4 v3, s[16:19], s72 offen lds
    s_add_u32 m0, s99, 0x18c00
    s_add_u32 s73, s88, 0x16000
    buffer_load_dwordx4 v3, s[16:19], s73 offen lds
    s_waitcnt lgkmcnt(1)
    v_add_f32 v120, v120, v80
    v_add_f32 v121, v121, v81
    v_add_f32 v122, v122, v82
    v_add_f32 v123, v123, v83
    s_waitcnt lgkmcnt(0)
    v_add_f32 v124, v124, v84
    v_add_f32 v125, v125, v85
    v_add_f32 v126, v126, v86
    v_add_f32 v127, v127, v87
    v_mul_f32 v64, v13, v120
    v_mul_f32 v65, v13, v121
    v_exp_f32 v64, v64
    v_mul_f32 v66, v13, v122
    v_exp_f32 v65, v65
    v_fma_f32 v64, v64, v14, v14
    v_mul_f32 v67, v13, v123
    v_exp_f32 v66, v66
    v_fma_f32 v65, v65, v14, v14
    v_rcp_f32 v64, v64
    v_mul_f32 v68, v13, v124
    v_exp_f32 v67, v67
    v_fma_f32 v66, v66, v14, v14
    v_rcp_f32 v65, v65
    v_mul_f32 v64, v120, v64
    v_mul_f32 v69, v13, v125
    v_exp_f32 v68, v68
    v_fma_f32 v67, v67, v14, v14
    v_rcp_f32 v66, v66
    v_mul_f32 v65, v121, v65
    v_cvt_pk_bf16_f32 v56, v64, v65
    v_mul_f32 v70, v13, v126
    v_exp_f32 v69, v69
    v_fma_f32 v68, v68, v14, v14
    v_rcp_f32 v67, v67
    v_mul_f32 v66, v122, v66
    v_mul_f32 v71, v13, v127
    v_exp_f32 v70, v70
    v_fma_f32 v69, v69, v14, v14
    v_rcp_f32 v68, v68
    v_mul_f32 v67, v123, v67
    v_cvt_pk_bf16_f32 v57, v66, v67
    v_exp_f32 v71, v71
    v_fma_f32 v70, v70, v14, v14
    v_rcp_f32 v69, v69
    v_mul_f32 v68, v124, v68
    v_fma_f32 v71, v71, v14, v14
    v_rcp_f32 v70, v70
    v_mul_f32 v69, v125, v69
    v_cvt_pk_bf16_f32 v58, v68, v69
    v_rcp_f32 v71, v71
    v_mul_f32 v70, v126, v70
    v_mul_f32 v71, v127, v71
    v_cvt_pk_bf16_f32 v59, v70, v71
    buffer_store_dwordx4 v[56:59], v2, s[24:27], s71 offen sc1
    s_add_u32 s74, s90, 0
    buffer_load_dwordx4 v[128:131], v2, s[24:27], s74 offen offset:0 sc1
    buffer_load_dwordx4 v[132:135], v2, s[24:27], s74 offen offset:1024 sc1
    buffer_load_dwordx4 v[136:139], v2, s[24:27], s74 offen offset:2048 sc1
    buffer_load_dwordx4 v[140:143], v2, s[24:27], s74 offen offset:3072 sc1
    s_add_u32 s74, s90, 12288
    buffer_load_dwordx4 v[144:147], v2, s[24:27], s74 offen offset:0 sc1
    buffer_load_dwordx4 v[148:151], v2, s[24:27], s74 offen offset:1024 sc1
    buffer_load_dwordx4 v[152:155], v2, s[24:27], s74 offen offset:2048 sc1
    buffer_load_dwordx4 v[156:159], v2, s[24:27], s74 offen offset:3072 sc1
    s_cmp_lg_u32 s54, 0
    s_cbranch_scc1 L_p0i_146
    s_add_u32 s75, s92, 3072
    buffer_load_dword v0, off, s[24:27], s75 sc1
L_p0i_146:
L_s2:
    v_lshrrev_b32 v6, 9, v2
    v_lshlrev_b32 v6, 9, v6
    v_sub_u32 v4, v4, v6
    s_lshr_b32 s95, s55, 1
    s_xor_b32 s95, s95, s56
    s_lshl_b32 s95, s95, 6
    s_and_b32 s96, s55, 1
    s_lshl_b32 s96, s96, 5
    s_or_b32 s95, s95, s96
    v_xor_b32 v4, s95, v4
    s_lshl_b32 s96, s55, 13
    v_add_u32 v8, s96, v4
    v_add_u32 v9, 0x10000, v8
    v_xor_b32 v10, 64, v8
    v_add_u32 v11, 0x10000, v10
    s_lshl_b32 s96, s59, 6
    s_lshl_b32 s97, s56, 5
    s_add_u32 s96, s96, s97
    s_lshl_b32 s96, s96, 10
    s_lshl_b32 s97, s60, 7
    s_add_u32 s96, s96, s97
    s_lshl_b32 s97, s55, 5
    s_add_u32 s96, s96, s97
    v_lshrrev_b32 v6, 4, v2
    v_and_b32 v6, 31, v6
    v_lshlrev_b32 v6, 10, v6
    v_lshrrev_b32 v7, 9, v2
    v_lshl_add_u32 v6, v7, 4, v6
    v_add_u32 v5, s96, v6
    s_waitcnt vmcnt(16) lgkmcnt(0)
    s_barrier
    s_add_u32 m0, s99, 0x8000
    s_add_u32 s73, s88, 0x40000
    buffer_load_dwordx4 v3, s[16:19], s73 offen lds
    s_add_u32 m0, s99, 0x8400
    s_add_u32 s72, s88, 0x42000
    buffer_load_dwordx4 v3, s[16:19], s72 offen lds
    s_add_u32 m0, s99, 0x8800
    s_add_u32 s73, s88, 0x44000
    buffer_load_dwordx4 v3, s[16:19], s73 offen lds
    s_add_u32 m0, s99, 0x8c00
    s_add_u32 s72, s88, 0x46000
    buffer_load_dwordx4 v3, s[16:19], s72 offen lds
    buffer_load_dwordx4 v[12:15], v5, s[8:11], 0 offen
    ds_read_b64_tr_b16 v[80:81], v8 offset:0
    ds_read_b64_tr_b16 v[82:83], v8 offset:1024
    ds_read_b64_tr_b16 v[84:85], v10 offset:0
    ds_read_b64_tr_b16 v[86:87], v10 offset:1024
    ds_read_b64_tr_b16 v[88:89], v8 offset:2048
    ds_read_b64_tr_b16 v[90:91], v8 offset:3072
    ds_read_b64_tr_b16 v[92:93], v10 offset:2048
    ds_read_b64_tr_b16 v[94:95], v10 offset:3072
    s_waitcnt vmcnt(12)
    s_waitcnt lgkmcnt(6)
    v_mfma_f32_32x32x16_bf16 v[16:31], v[80:83], v[128:131], 0
    ds_read_b64_tr_b16 v[96:97], v8 offset:4096
    ds_read_b64_tr_b16 v[98:99], v8 offset:5120
    s_waitcnt lgkmcnt(6)
    v_mfma_f32_32x32x16_bf16 v[32:47], v[84:87], v[128:131], 0
    ds_read_b64_tr_b16 v[100:101], v10 offset:4096
    ds_read_b64_tr_b16 v[102:103], v10 offset:5120
    s_cmp_eq_u32 s77, 1
    s_waitcnt lgkmcnt(0)
    s_cbranch_scc1 L_pa2_skip
    s_cmp_lg_u32 s54, 0
    s_cbranch_scc1 L_pa2_ok
    s_waitcnt vmcnt(5)
    v_readfirstlane_b32 s83, v0
    s_nop 0
    s_cmp_eq_u32 s83, 8
    s_cbranch_scc1 L_pa2_ok
    s_mov_b32 s86, 0
    s_add_u32 s75, s92, 3072
L_pa2:
    buffer_load_dword v0, off, s[24:27], s75 sc1
    s_add_u32 s86, s86, 1
    s_waitcnt vmcnt(0)
    v_readfirstlane_b32 s83, v0
    s_cmp_gt_u32 s86, 0x10000
    s_cbranch_scc1 L_pa2_to
    s_cmp_lg_u32 s83, 8
    s_cbranch_scc1 L_pa2
L_pa2_to:
L_pa2_ok:
L_pa2_skip:
    s_waitcnt vmcnt(17)
    s_barrier
    s_cmp_eq_u32 s77, 1
    s_cbranch_scc1 L_sigFB
    s_cmp_lg_u32 s54, 0
    s_cbranch_scc1 L_sigFB_
    s_add_u32 s75, s93, 5120
    v_mov_b32 v6, 1
    s_mov_b64 exec, 1
    buffer_atomic_add v6, off, s[24:27], s75
    s_mov_b64 exec, -1
L_sigFB_:
L_sigFB:
    s_waitcnt vmcnt(11)
    v_mfma_f32_32x32x16_bf16 v[16:31], v[88:91], v[132:135], v[16:31]
    s_add_u32 s98, s90, 4096
    buffer_load_dwordx4 v[160:163], v2, s[24:27], s98 offen offset:0 sc1
    ds_read_b64_tr_b16 v[80:81], v8 offset:6144
    ds_read_b64_tr_b16 v[82:83], v8 offset:7168
    v_mfma_f32_32x32x16_bf16 v[32:47], v[92:95], v[132:135], v[32:47]
    buffer_load_dwordx4 v[164:167], v2, s[24:27], s98 offen offset:1024 sc1
    ds_read_b64_tr_b16 v[84:85], v10 offset:6144
    ds_read_b64_tr_b16 v[86:87], v10 offset:7168
    s_waitcnt vmcnt(12)
    v_mfma_f32_32x32x16_bf16 v[16:31], v[96:99], v[136:139], v[16:31]
    buffer_load_dwordx4 v[168:171], v2, s[24:27], s98 offen offset:2048 sc1
    ds_read_b64_tr_b16 v[88:89], v9 offset:0
    ds_read_b64_tr_b16 v[90:91], v9 offset:1024
    v_mfma_f32_32x32x16_bf16 v[32:47], v[100:103], v[136:139], v[32:47]
    ds_read_b64_tr_b16 v[92:93], v11 offset:0
    ds_read_b64_tr_b16 v[94:95], v11 offset:1024
    s_waitcnt vmcnt(12)
    s_waitcnt lgkmcnt(6)
    v_mfma_f32_32x32x16_bf16 v[16:31], v[80:83], v[140:143], v[16:31]
    buffer_load_dwordx4 v[172:175], v2, s[24:27], s98 offen offset:3072 sc1
    ds_read_b64_tr_b16 v[96:97], v9 offset:2048
    ds_read_b64_tr_b16 v[98:99], v9 offset:3072
    s_waitcnt lgkmcnt(6)
    v_mfma_f32_32x32x16_bf16 v[32:47], v[84:87], v[140:143], v[32:47]
    ds_read_b64_tr_b16 v[100:101], v11 offset:2048
    ds_read_b64_tr_b16 v[102:103], v11 offset:3072
    s_waitcnt vmcnt(12)
    s_waitcnt lgkmcnt(6)
    v_mfma_f32_32x32x16_bf16 v[16:31], v[88:91], v[144:147], v[16:31]
    s_add_u32 s98, s90, 16384
    buffer_load_dwordx4 v[176:179], v2, s[24:27], s98 offen offset:0 sc1
    ds_read_b64_tr_b16 v[80:81], v9 offset:4096
    ds_read_b64_tr_b16 v[82:83], v9 offset:5120
    s_waitcnt lgkmcnt(6)
    v_mfma_f32_32x32x16_bf16 v[32:47], v[92:95], v[144:147], v[32:47]
    ds_read_b64_tr_b16 v[84:85], v11 offset:4096
    ds_read_b64_tr_b16 v[86:87], v11 offset:5120
    s_waitcnt vmcnt(18)
    s_barrier
    s_waitcnt vmcnt(12)
    s_waitcnt lgkmcnt(6)
    v_mfma_f32_32x32x16_bf16 v[16:31], v[96:99], v[148:151], v[16:31]
    buffer_load_dwordx4 v[180:183], v2, s[24:27], s98 offen offset:1024 sc1
    ds_read_b64_tr_b16 v[88:89], v9 offset:6144
    ds_read_b64_tr_b16 v[90:91], v9 offset:7168
    s_waitcnt lgkmcnt(6)
    v_mfma_f32_32x32x16_bf16 v[32:47], v[100:103], v[148:151], v[32:47]
    s_mov_b32 m0, s99
    s_add_u32 s73, s88, 0x20000
    buffer_load_dwordx4 v3, s[16:19], s73 offen lds
    ds_read_b64_tr_b16 v[92:93], v11 offset:6144
    ds_read_b64_tr_b16 v[94:95], v11 offset:7168
    s_waitcnt vmcnt(13)
    s_waitcnt lgkmcnt(6)
    v_mfma_f32_32x32x16_bf16 v[16:31], v[80:83], v[152:155], v[16:31]
    buffer_load_dwordx4 v[184:187], v2, s[24:27], s98 offen offset:2048 sc1
    ds_read_b64_tr_b16 v[96:97], v9 offset:32768
    ds_read_b64_tr_b16 v[98:99], v9 offset:33792
    s_waitcnt lgkmcnt(6)
    v_mfma_f32_32x32x16_bf16 v[32:47], v[84:87], v[152:155], v[32:47]
    s_add_u32 m0, s99, 0x400
    s_add_u32 s72, s88, 0x22000
    buffer_load_dwordx4 v3, s[16:19], s72 offen lds
    ds_read_b64_tr_b16 v[100:101], v11 offset:32768
    ds_read_b64_tr_b16 v[102:103], v11 offset:33792
    s_waitcnt vmcnt(14)
    s_waitcnt lgkmcnt(6)
    v_mfma_f32_32x32x16_bf16 v[16:31], v[88:91], v[156:159], v[16:31]
    buffer_load_dwordx4 v[188:191], v2, s[24:27], s98 offen offset:3072 sc1
    ds_read_b64_tr_b16 v[80:81], v9 offset:34816
    ds_read_b64_tr_b16 v[82:83], v9 offset:35840
    s_waitcnt lgkmcnt(6)
    v_mfma_f32_32x32x16_bf16 v[32:47], v[92:95], v[156:159], v[32:47]
    s_add_u32 m0, s99, 0x800
    s_add_u32 s73, s88, 0x24000
    buffer_load_dwordx4 v3, s[16:19], s73 offen lds
    ds_read_b64_tr_b16 v[84:85], v11 offset:34816
    ds_read_b64_tr_b16 v[86:87], v11 offset:35840
    s_waitcnt vmcnt(10)
    s_waitcnt lgkmcnt(6)
    v_mfma_f32_32x32x16_bf16 v[16:31], v[96:99], v[160:163], v[16:31]
    ds_read_b64_tr_b16 v[88:89], v9 offset:36864
    ds_read_b64_tr_b16 v[90:91], v9 offset:37888
    s_waitcnt lgkmcnt(6)
    v_mfma_f32_32x32x16_bf16 v[32:47], v[100:103], v[160:163], v[32:47]
    s_add_u32 m0, s99, 0xc00
    s_add_u32 s72, s88, 0x26000
    buffer_load_dwordx4 v3, s[16:19], s72 offen lds
    ds_read_b64_tr_b16 v[92:93], v11 offset:36864
    ds_read_b64_tr_b16 v[94:95], v11 offset:37888
    s_waitcnt vmcnt(13)
    s_barrier
    s_cmp_eq_u32 s77, 0
    s_waitcnt lgkmcnt(0)
    s_cbranch_scc1 L_sigL
    s_cmp_lg_u32 s54, 0
    s_cbranch_scc1 L_sigL_
    s_add_u32 s75, s93, 7168
    v_mov_b32 v6, 1
    s_mov_b64 exec, 1
    buffer_atomic_add v6, off, s[24:27], s75
    s_mov_b64 exec, -1
L_sigL_:
L_sigL:
    s_waitcnt vmcnt(10)
    v_mfma_f32_32x32x16_bf16 v[16:31], v[80:83], v[164:167], v[16:31]
    ds_read_b64_tr_b16 v[96:97], v9 offset:38912
    ds_read_b64_tr_b16 v[98:99], v9 offset:39936
    v_mfma_f32_32x32x16_bf16 v[32:47], v[84:87], v[164:167], v[32:47]
    s_add_u32 m0, s99, 0x10000
    s_add_u32 s73, s88, 0x50000
    buffer_load_dwordx4 v3, s[16:19], s73 offen lds
    ds_read_b64_tr_b16 v[100:101], v11 offset:38912
    ds_read_b64_tr_b16 v[102:103], v11 offset:39936
    s_waitcnt vmcnt(10)
    v_mfma_f32_32x32x16_bf16 v[16:31], v[88:91], v[168:171], v[16:31]
    ds_read_b64_tr_b16 v[80:81], v8 offset:32768
    ds_read_b64_tr_b16 v[82:83], v8 offset:33792
    v_mfma_f32_32x32x16_bf16 v[32:47], v[92:95], v[168:171], v[32:47]
    s_add_u32 m0, s99, 0x10400
    s_add_u32 s72, s88, 0x52000
    buffer_load_dwordx4 v3, s[16:19], s72 offen lds
    ds_read_b64_tr_b16 v[84:85], v10 offset:32768
    ds_read_b64_tr_b16 v[86:87], v10 offset:33792
    s_cmp_lg_u32 s54, 0
    s_cbranch_scc1 L_p0i_157
    s_add_u32 s75, s92, 5120
    buffer_load_dword v0, off, s[24:27], s75 sc1
L_p0i_157:
    s_waitcnt vmcnt(10)
    s_waitcnt lgkmcnt(6)
    v_mfma_f32_32x32x16_bf16 v[16:31], v[96:99], v[172:175], v[16:31]
    ds_read_b64_tr_b16 v[88:89], v8 offset:34816
    ds_read_b64_tr_b16 v[90:91], v8 offset:35840
    s_waitcnt lgkmcnt(6)
    v_mfma_f32_32x32x16_bf16 v[32:47], v[100:103], v[172:175], v[32:47]
    s_add_u32 m0, s99, 0x10800
    s_add_u32 s72, s88, 0x54000
    buffer_load_dwordx4 v3, s[16:19], s72 offen lds
    ds_read_b64_tr_b16 v[92:93], v10 offset:34816
    ds_read_b64_tr_b16 v[94:95], v10 offset:35840
    s_waitcnt vmcnt(10)
    s_waitcnt lgkmcnt(6)
    v_mfma_f32_32x32x16_bf16 v[16:31], v[80:83], v[176:179], v[16:31]
    ds_read_b64_tr_b16 v[96:97], v8 offset:36864
    ds_read_b64_tr_b16 v[98:99], v8 offset:37888
    s_waitcnt lgkmcnt(6)
    v_mfma_f32_32x32x16_bf16 v[32:47], v[84:87], v[176:179], v[32:47]
    s_add_u32 m0, s99, 0x10c00
    s_add_u32 s73, s88, 0x56000
    buffer_load_dwordx4 v3, s[16:19], s73 offen lds
    ds_read_b64_tr_b16 v[100:101], v10 offset:36864
    ds_read_b64_tr_b16 v[102:103], v10 offset:37888
    s_cmp_lg_u32 s54, 0
    s_waitcnt lgkmcnt(0)
    s_cbranch_scc1 L_pb_ok
    s_waitcnt vmcnt(2)
    v_readfirstlane_b32 s83, v0
    s_nop 0
    s_cmp_eq_u32 s83, 8
    s_cbranch_scc1 L_pb_ok
    s_mov_b32 s86, 0
    s_add_u32 s75, s92, 5120
L_pb:
    buffer_load_dword v0, off, s[24:27], s75 sc1
    s_add_u32 s86, s86, 1
    s_waitcnt vmcnt(0)
    v_readfirstlane_b32 s83, v0
    s_cmp_gt_u32 s86, 0x10000
    s_cbranch_scc1 L_pb_to
    s_cmp_lg_u32 s83, 8
    s_cbranch_scc1 L_pb
L_pb_to:
L_pb_ok:
    s_waitcnt vmcnt(4)
    s_barrier
    s_waitcnt vmcnt(10)
    v_mfma_f32_32x32x16_bf16 v[16:31], v[88:91], v[180:183], v[16:31]
    s_add_u32 s98, s90, 8192
    buffer_load_dwordx4 v[192:195], v2, s[24:27], s98 offen offset:0 sc1
    ds_read_b64_tr_b16 v[80:81], v8 offset:38912
    ds_read_b64_tr_b16 v[82:83], v8 offset:39936
    v_mfma_f32_32x32x16_bf16 v[32:47], v[92:95], v[180:183], v[32:47]
    buffer_load_dwordx4 v[196:199], v2, s[24:27], s98 offen offset:1024 sc1
    s_add_u32 m0, s99, 0x18000
    s_add_u32 s72, s82, 0x0
    buffer_load_dwordx4 v3, s[16:19], s72 offen lds
    ds_read_b64_tr_b16 v[84:85], v10 offset:38912
    ds_read_b64_tr_b16 v[86:87], v10 offset:39936
    s_waitcnt vmcnt(11)
    v_mfma_f32_32x32x16_bf16 v[16:31], v[96:99], v[184:187], v[16:31]
    buffer_load_dwordx4 v[200:203], v2, s[24:27], s98 offen offset:2048 sc1
    ds_read_b64_tr_b16 v[88:89], v8 offset:0
    ds_read_b64_tr_b16 v[90:91], v8 offset:1024
    v_mfma_f32_32x32x16_bf16 v[32:47], v[100:103], v[184:187], v[32:47]
    buffer_load_dwordx4 v[204:207], v2, s[24:27], s98 offen offset:3072 sc1
    s_add_u32 m0, s99, 0x18400
    s_add_u32 s73, s82, 0x2000
    buffer_load_dwordx4 v3, s[16:19], s73 offen lds
    ds_read_b64_tr_b16 v[92:93], v10 offset:0
    ds_read_b64_tr_b16 v[94:95], v10 offset:1024
    s_waitcnt vmcnt(12)
    s_waitcnt lgkmcnt(6)
    v_mfma_f32_32x32x16_bf16 v[16:31], v[80:83], v[188:191], v[16:31]
    s_add_u32 s98, s90, 20480
    buffer_load_dwordx4 v[208:211], v2, s[24:27], s98 offen offset:0 sc1
    ds_read_b64_tr_b16 v[96:97], v8 offset:2048
    ds_read_b64_tr_b16 v[98:99], v8 offset:3072
    s_waitcnt lgkmcnt(6)
    v_mfma_f32_32x32x16_bf16 v[32:47], v[84:87], v[188:191], v[32:47]
    buffer_load_dwordx4 v[212:215], v2, s[24:27], s98 offen offset:1024 sc1
    s_add_u32 m0, s99, 0x18800
    s_add_u32 s72, s82, 0x4000
    buffer_load_dwordx4 v3, s[16:19], s72 offen lds
    ds_read_b64_tr_b16 v[100:101], v10 offset:2048
    ds_read_b64_tr_b16 v[102:103], v10 offset:3072
    s_waitcnt vmcnt(8)
    s_waitcnt lgkmcnt(6)
    v_mfma_f32_32x32x16_bf16 v[16:31], v[88:91], v[192:195], v[16:31]
    buffer_load_dwordx4 v[216:219], v2, s[24:27], s98 offen offset:2048 sc1
    ds_read_b64_tr_b16 v[80:81], v8 offset:4096
    ds_read_b64_tr_b16 v[82:83], v8 offset:5120
    s_waitcnt lgkmcnt(6)
    v_mfma_f32_32x32x16_bf16 v[32:47], v[92:95], v[192:195], v[32:47]
    buffer_load_dwordx4 v[220:223], v2, s[24:27], s98 offen offset:3072 sc1
    s_add_u32 m0, s99, 0x18c00
    s_add_u32 s73, s82, 0x6000
    buffer_load_dwordx4 v3, s[16:19], s73 offen lds
    ds_read_b64_tr_b16 v[84:85], v10 offset:4096
    ds_read_b64_tr_b16 v[86:87], v10 offset:5120
    s_waitcnt vmcnt(12)
    s_barrier
    s_waitcnt vmcnt(10)
    s_waitcnt lgkmcnt(6)
    v_mfma_f32_32x32x16_bf16 v[16:31], v[96:99], v[196:199], v[16:31]
    s_add_u32 s98, s100, 0
    buffer_load_dwordx4 v[224:227], v2, s[24:27], s98 offen offset:0 sc1
    ds_read_b64_tr_b16 v[88:89], v8 offset:6144
    ds_read_b64_tr_b16 v[90:91], v8 offset:7168
    s_waitcnt lgkmcnt(6)
    v_mfma_f32_32x32x16_bf16 v[32:47], v[100:103], v[196:199], v[32:47]
    buffer_load_dwordx4 v[228:231], v2, s[24:27], s98 offen offset:1024 sc1
    s_add_u32 m0, s99, 0x8000
    s_add_u32 s72, s89, 0x0
    buffer_load_dwordx4 v3, s[20:23], s72 offen lds
    ds_read_b64_tr_b16 v[92:93], v10 offset:6144
    ds_read_b64_tr_b16 v[94:95], v10 offset:7168
    s_waitcnt vmcnt(11)
    s_waitcnt lgkmcnt(6)
    v_mfma_f32_32x32x16_bf16 v[16:31], v[80:83], v[200:203], v[16:31]
    buffer_load_dwordx4 v[232:235], v2, s[24:27], s98 offen offset:2048 sc1
    ds_read_b64_tr_b16 v[96:97], v9 offset:0
    ds_read_b64_tr_b16 v[98:99], v9 offset:1024
    s_waitcnt lgkmcnt(6)
    v_mfma_f32_32x32x16_bf16 v[32:47], v[84:87], v[200:203], v[32:47]
    s_add_u32 m0, s99, 0x8400
    s_add_u32 s73, s89, 0x2000
    buffer_load_dwordx4 v3, s[20:23], s73 offen lds
    ds_read_b64_tr_b16 v[100:101], v11 offset:0
    ds_read_b64_tr_b16 v[102:103], v11 offset:1024
    s_cmp_lg_u32 s54, 0
    s_cbranch_scc1 L_p0i_166
    s_add_u32 s75, s92, 7168
    buffer_load_dword v0, off, s[24:27], s75 sc1
L_p0i_166:
    s_waitcnt vmcnt(12)
    s_waitcnt lgkmcnt(6)
    v_mfma_f32_32x32x16_bf16 v[16:31], v[88:91], v[204:207], v[16:31]
    buffer_load_dwordx4 v[236:239], v2, s[24:27], s98 offen offset:3072 sc1
    ds_read_b64_tr_b16 v[80:81], v9 offset:2048
    ds_read_b64_tr_b16 v[82:83], v9 offset:3072
    s_waitcnt lgkmcnt(6)
    v_mfma_f32_32x32x16_bf16 v[32:47], v[92:95], v[204:207], v[32:47]
    s_add_u32 m0, s99, 0x8800
    s_add_u32 s73, s89, 0x4000
    buffer_load_dwordx4 v3, s[20:23], s73 offen lds
    ds_read_b64_tr_b16 v[84:85], v11 offset:2048
    ds_read_b64_tr_b16 v[86:87], v11 offset:3072
    s_waitcnt vmcnt(12)
    s_waitcnt lgkmcnt(6)
    v_mfma_f32_32x32x16_bf16 v[16:31], v[96:99], v[208:211], v[16:31]
    ds_read_b64_tr_b16 v[88:89], v9 offset:4096
    ds_read_b64_tr_b16 v[90:91], v9 offset:5120
    s_waitcnt lgkmcnt(6)
    v_mfma_f32_32x32x16_bf16 v[32:47], v[100:103], v[208:211], v[32:47]
    s_add_u32 m0, s99, 0x8c00
    s_add_u32 s72, s89, 0x6000
    buffer_load_dwordx4 v3, s[20:23], s72 offen lds
    ds_read_b64_tr_b16 v[92:93], v11 offset:4096
    ds_read_b64_tr_b16 v[94:95], v11 offset:5120
    s_cmp_lg_u32 s54, 0
    s_waitcnt lgkmcnt(0)
    s_cbranch_scc1 L_pl_ok
    s_waitcnt vmcnt(3)
    v_readfirstlane_b32 s83, v0
    s_nop 0
    s_cmp_eq_u32 s83, 8
    s_cbranch_scc1 L_pl_ok
    s_mov_b32 s86, 0
    s_add_u32 s75, s92, 7168
L_pl:
    buffer_load_dword v0, off, s[24:27], s75 sc1
    s_add_u32 s86, s86, 1
    s_waitcnt vmcnt(0)
    v_readfirstlane_b32 s83, v0
    s_cmp_gt_u32 s86, 0x10000
    s_cbranch_scc1 L_pl_to
    s_cmp_lg_u32 s83, 8
    s_cbranch_scc1 L_pl
L_pl_to:
L_pl_ok:
    s_waitcnt vmcnt(8)
    s_barrier
    s_waitcnt vmcnt(12)
    v_mfma_f32_32x32x16_bf16 v[16:31], v[80:83], v[212:215], v[16:31]
    s_add_u32 s98, s91, 0
    buffer_load_dwordx4 v[240:243], v2, s[24:27], s98 offen offset:0 sc1
    ds_read_b64_tr_b16 v[96:97], v9 offset:6144
    ds_read_b64_tr_b16 v[98:99], v9 offset:7168
    v_mfma_f32_32x32x16_bf16 v[32:47], v[84:87], v[212:215], v[32:47]
    buffer_load_dwordx4 v[244:247], v2, s[24:27], s98 offen offset:1024 sc1
    s_mov_b32 m0, s99
    s_add_u32 s73, s89, 0x10000
    buffer_load_dwordx4 v3, s[20:23], s73 offen lds
    ds_read_b64_tr_b16 v[100:101], v11 offset:6144
    ds_read_b64_tr_b16 v[102:103], v11 offset:7168
    s_waitcnt vmcnt(13)
    v_mfma_f32_32x32x16_bf16 v[16:31], v[88:91], v[216:219], v[16:31]
    buffer_load_dwordx4 v[104:107], v2, s[24:27], s98 offen offset:2048 sc1
    ds_read_b64_tr_b16 v[80:81], v9 offset:32768
    ds_read_b64_tr_b16 v[82:83], v9 offset:33792
    v_mfma_f32_32x32x16_bf16 v[32:47], v[92:95], v[216:219], v[32:47]
    s_add_u32 m0, s99, 0x400
    s_add_u32 s72, s89, 0x12000
    buffer_load_dwordx4 v3, s[20:23], s72 offen lds
    ds_read_b64_tr_b16 v[84:85], v11 offset:32768
    ds_read_b64_tr_b16 v[86:87], v11 offset:33792
    s_lshl_b32 s95, s56, 2
    s_xor_b32 s96, s55, 1
    s_add_u32 s96, s96, s95
    s_mul_i32 s96, s96, 12288
    s_add_u32 s96, s96, 0x10000
    v_add_u32 v193, s96, v2
    s_lshl_b32 s95, s56, 2
    s_xor_b32 s96, s55, 2
    s_add_u32 s96, s96, s95
    s_mul_i32 s96, s96, 12288
    s_add_u32 s96, s96, 0x11000
    v_add_u32 v194, s96, v2
    s_lshl_b32 s95, s56, 2
    s_xor_b32 s96, s55, 3
    s_add_u32 s96, s96, s95
    s_mul_i32 s96, s96, 12288
    s_add_u32 s96, s96, 0x12000
    v_add_u32 v195, s96, v2
    s_lshl_b32 s95, s56, 2
    s_add_u32 s96, s55, s95
    s_mul_i32 s97, s96, 12288
    s_add_u32 s97, s97, 0x10000
    v_add_u32 v192, s97, v2
    s_waitcnt vmcnt(14)
    s_waitcnt lgkmcnt(6)
    v_mfma_f32_32x32x16_bf16 v[16:31], v[96:99], v[220:223], v[16:31]
    buffer_load_dwordx4 v[108:111], v2, s[24:27], s98 offen offset:3072 sc1
    ds_read_b64_tr_b16 v[88:89], v9 offset:34816
    ds_read_b64_tr_b16 v[90:91], v9 offset:35840
    s_waitcnt lgkmcnt(6)
    v_mfma_f32_32x32x16_bf16 v[32:47], v[100:103], v[220:223], v[32:47]
    s_add_u32 m0, s99, 0x800
    s_add_u32 s73, s89, 0x14000
    buffer_load_dwordx4 v3, s[20:23], s73 offen lds
    ds_read_b64_tr_b16 v[92:93], v11 offset:34816
    ds_read_b64_tr_b16 v[94:95], v11 offset:35840
    s_waitcnt vmcnt(14)
    s_waitcnt lgkmcnt(6)
    v_mfma_f32_32x32x16_bf16 v[16:31], v[80:83], v[224:227], v[16:31]
    s_add_u32 s98, s91, 4096
    buffer_load_dwordx4 v[112:115], v2, s[24:27], s98 offen offset:0 sc1
    ds_read_b64_tr_b16 v[96:97], v9 offset:36864
    ds_read_b64_tr_b16 v[98:99], v9 offset:37888
    s_waitcnt lgkmcnt(6)
    v_mfma_f32_32x32x16_bf16 v[32:47], v[84:87], v[224:227], v[32:47]
    s_add_u32 m0, s99, 0xc00
    s_add_u32 s72, s89, 0x16000
    buffer_load_dwordx4 v3, s[20:23], s72 offen lds
    ds_read_b64_tr_b16 v[100:101], v11 offset:36864
    ds_read_b64_tr_b16 v[102:103], v11 offset:37888
    s_waitcnt vmcnt(9)
    s_barrier
    s_waitcnt vmcnt(15)
    s_waitcnt lgkmcnt(6)
    v_mfma_f32_32x32x16_bf16 v[16:31], v[88:91], v[228:231], v[16:31]
    buffer_load_dwordx4 v[116:119], v2, s[24:27], s98 offen offset:1024 sc1
    ds_read_b64_tr_b16 v[80:81], v9 offset:38912
    ds_read_b64_tr_b16 v[82:83], v9 offset:39936
    s_waitcnt lgkmcnt(6)
    v_mfma_f32_32x32x16_bf16 v[32:47], v[92:95], v[228:231], v[32:47]
    ds_read_b64_tr_b16 v[84:85], v11 offset:38912
    ds_read_b64_tr_b16 v[86:87], v11 offset:39936
    s_waitcnt vmcnt(14)
    s_waitcnt lgkmcnt(6)
    v_mfma_f32_32x32x16_bf16 v[16:31], v[96:99], v[232:235], v[16:31]
    buffer_load_dwordx4 v[120:123], v2, s[24:27], s98 offen offset:2048 sc1
    ds_read_b64_tr_b16 v[88:89], v8 offset:32768
    ds_read_b64_tr_b16 v[90:91], v8 offset:33792
    s_waitcnt lgkmcnt(6)
    v_mfma_f32_32x32x16_bf16 v[32:47], v[100:103], v[232:235], v[32:47]
    ds_read_b64_tr_b16 v[92:93], v10 offset:32768
    ds_read_b64_tr_b16 v[94:95], v10 offset:33792
    s_waitcnt vmcnt(13)
    s_waitcnt lgkmcnt(6)
    v_mfma_f32_32x32x16_bf16 v[16:31], v[80:83], v[236:239], v[16:31]
    buffer_load_dwordx4 v[124:127], v2, s[24:27], s98 offen offset:3072 sc1
    ds_read_b64_tr_b16 v[96:97], v8 offset:34816
    ds_read_b64_tr_b16 v[98:99], v8 offset:35840
    s_waitcnt lgkmcnt(6)
    v_mfma_f32_32x32x16_bf16 v[32:47], v[84:87], v[236:239], v[32:47]
    ds_read_b64_tr_b16 v[100:101], v10 offset:34816
    ds_read_b64_tr_b16 v[102:103], v10 offset:35840
    s_waitcnt vmcnt(11)
    s_waitcnt lgkmcnt(6)
    v_mfma_f32_32x32x16_bf16 v[48:63], v[88:91], v[240:243], 0
    ds_read_b64_tr_b16 v[80:81], v8 offset:36864
    ds_read_b64_tr_b16 v[82:83], v8 offset:37888
    s_waitcnt lgkmcnt(6)
    v_mfma_f32_32x32x16_bf16 v[64:79], v[92:95], v[240:243], 0
    ds_read_b64_tr_b16 v[84:85], v10 offset:36864
    ds_read_b64_tr_b16 v[86:87], v10 offset:37888
    s_waitcnt vmcnt(3)
    s_barrier
    s_waitcnt vmcnt(10)
    s_waitcnt lgkmcnt(6)
    v_mfma_f32_32x32x16_bf16 v[48:63], v[96:99], v[244:247], v[48:63]
    ds_read_b64_tr_b16 v[88:89], v8 offset:38912
    ds_read_b64_tr_b16 v[90:91], v8 offset:39936
    s_waitcnt lgkmcnt(6)
    v_mfma_f32_32x32x16_bf16 v[64:79], v[100:103], v[244:247], v[64:79]
    ds_read_b64_tr_b16 v[92:93], v10 offset:38912
    ds_read_b64_tr_b16 v[94:95], v10 offset:39936
    ds_write_b128 v193, v[24:27]
    ds_write_b128 v193, v[28:31] offset:1024
    s_waitcnt vmcnt(8)
    s_waitcnt lgkmcnt(8)
    v_mfma_f32_32x32x16_bf16 v[48:63], v[80:83], v[104:107], v[48:63]
    ds_read_b64_tr_b16 v[96:97], v8 offset:0
    ds_read_b64_tr_b16 v[98:99], v8 offset:1024
    s_waitcnt lgkmcnt(8)
    v_mfma_f32_32x32x16_bf16 v[64:79], v[84:87], v[104:107], v[64:79]
    ds_read_b64_tr_b16 v[100:101], v10 offset:0
    ds_read_b64_tr_b16 v[102:103], v10 offset:1024
    ds_write_b128 v194, v[32:35]
    ds_write_b128 v194, v[36:39] offset:1024
    s_waitcnt vmcnt(6)
    s_waitcnt lgkmcnt(10)
    v_mfma_f32_32x32x16_bf16 v[48:63], v[88:91], v[108:111], v[48:63]
    ds_read_b64_tr_b16 v[80:81], v8 offset:2048
    ds_read_b64_tr_b16 v[82:83], v8 offset:3072
    s_waitcnt lgkmcnt(10)
    v_mfma_f32_32x32x16_bf16 v[64:79], v[92:95], v[108:111], v[64:79]
    ds_read_b64_tr_b16 v[84:85], v10 offset:2048
    ds_read_b64_tr_b16 v[86:87], v10 offset:3072
    ds_write_b128 v195, v[40:43]
    ds_write_b128 v195, v[44:47] offset:1024
    s_waitcnt vmcnt(4)
    s_waitcnt lgkmcnt(10)
    v_mfma_f32_32x32x16_bf16 v[48:63], v[96:99], v[112:115], v[48:63]
    ds_read_b64_tr_b16 v[88:89], v8 offset:4096
    ds_read_b64_tr_b16 v[90:91], v8 offset:5120
    s_waitcnt lgkmcnt(10)
    v_mfma_f32_32x32x16_bf16 v[64:79], v[100:103], v[112:115], v[64:79]
    ds_read_b64_tr_b16 v[92:93], v10 offset:4096
    ds_read_b64_tr_b16 v[94:95], v10 offset:5120
    s_waitcnt lgkmcnt(4)
    s_barrier
    ds_read_b128 v[128:131], v192 offset:0
    ds_read_b128 v[144:147], v192 offset:4096
    ds_read_b128 v[160:163], v192 offset:8192
    ds_read_b128 v[132:135], v192 offset:1024
    ds_read_b128 v[148:151], v192 offset:5120
    ds_read_b128 v[164:167], v192 offset:9216
    s_waitcnt vmcnt(48)
    v_lshlrev_b32 v184, 16, v12
    v_and_b32 v185, 0xffff0000, v12
    v_lshlrev_b32 v186, 16, v13
    v_and_b32 v187, 0xffff0000, v13
    v_lshlrev_b32 v188, 16, v14
    v_and_b32 v189, 0xffff0000, v14
    v_lshlrev_b32 v190, 16, v15
    v_and_b32 v191, 0xffff0000, v15
    s_waitcnt vmcnt(2)
    v_mfma_f32_32x32x16_bf16 v[48:63], v[80:83], v[116:119], v[48:63]
    ds_read_b64_tr_b16 v[96:97], v8 offset:6144
    ds_read_b64_tr_b16 v[98:99], v8 offset:7168
    v_mfma_f32_32x32x16_bf16 v[64:79], v[84:87], v[116:119], v[64:79]
    ds_read_b64_tr_b16 v[100:101], v10 offset:6144
    ds_read_b64_tr_b16 v[102:103], v10 offset:7168
    s_waitcnt lgkmcnt(8)
    v_add_f32 v128, v128, v144
    v_add_f32 v129, v129, v145
    v_add_f32 v130, v130, v146
    v_add_f32 v131, v131, v147
    s_waitcnt lgkmcnt(5)
    v_add_f32 v132, v132, v148
    v_add_f32 v133, v133, v149
    v_add_f32 v134, v134, v150
    v_add_f32 v135, v135, v151
    v_add_f32 v16, v16, v160
    v_add_f32 v17, v17, v161
    v_add_f32 v18, v18, v162
    v_add_f32 v19, v19, v163
    s_waitcnt lgkmcnt(4)
    v_add_f32 v20, v20, v164
    v_add_f32 v21, v21, v165
    v_add_f32 v22, v22, v166
    v_add_f32 v23, v23, v167
    s_waitcnt vmcnt(1)
    v_mfma_f32_32x32x16_bf16 v[48:63], v[88:91], v[120:123], v[48:63]
    v_mfma_f32_32x32x16_bf16 v[64:79], v[92:95], v[120:123], v[64:79]
    v_add_f32 v16, v16, v128
    v_add_f32 v17, v17, v129
    v_add_f32 v18, v18, v130
    v_add_f32 v19, v19, v131
    v_add_f32 v20, v20, v132
    v_add_f32 v21, v21, v133
    v_add_f32 v22, v22, v134
    v_add_f32 v23, v23, v135
    v_mul_f32 v176, 0xbfb8aa3b, v16
    v_mul_f32 v177, 0xbfb8aa3b, v17
    v_mul_f32 v178, 0xbfb8aa3b, v18
    v_mul_f32 v179, 0xbfb8aa3b, v19
    v_mul_f32 v180, 0xbfb8aa3b, v20
    v_mul_f32 v181, 0xbfb8aa3b, v21
    v_mul_f32 v182, 0xbfb8aa3b, v22
    v_mul_f32 v183, 0xbfb8aa3b, v23
    s_waitcnt vmcnt(0)
    s_waitcnt lgkmcnt(2)
    v_mfma_f32_32x32x16_bf16 v[48:63], v[96:99], v[124:127], v[48:63]
    s_waitcnt lgkmcnt(0)
    v_mfma_f32_32x32x16_bf16 v[64:79], v[100:103], v[124:127], v[64:79]
    v_exp_f32 v176, v176
    v_exp_f32 v177, v177
    v_exp_f32 v178, v178
    v_exp_f32 v179, v179
    v_exp_f32 v180, v180
    v_exp_f32 v181, v181
    v_exp_f32 v182, v182
    v_exp_f32 v183, v183
    v_add_f32 v176, 1.0, v176
    v_add_f32 v177, 1.0, v177
    v_add_f32 v178, 1.0, v178
    v_add_f32 v179, 1.0, v179
    ds_write_b128 v193, v[56:59] offset:2048
    ds_write_b128 v193, v[60:63] offset:3072
    ds_write_b128 v194, v[64:67] offset:2048
    ds_write_b128 v194, v[68:71] offset:3072
    ds_write_b128 v195, v[72:75] offset:2048
    ds_write_b128 v195, v[76:79] offset:3072
    v_add_f32 v180, 1.0, v180
    v_add_f32 v181, 1.0, v181
    v_add_f32 v182, 1.0, v182
    v_add_f32 v183, 1.0, v183
    v_rcp_f32 v176, v176
    v_rcp_f32 v177, v177
    v_rcp_f32 v178, v178
    v_rcp_f32 v179, v179
    v_rcp_f32 v180, v180
    v_rcp_f32 v181, v181
    v_rcp_f32 v182, v182
    v_rcp_f32 v183, v183
    s_waitcnt lgkmcnt(0)
    s_barrier
    ds_read_b128 v[136:139], v192 offset:2048
    ds_read_b128 v[152:155], v192 offset:6144
    ds_read_b128 v[168:171], v192 offset:10240
    ds_read_b128 v[140:143], v192 offset:3072
    ds_read_b128 v[156:159], v192 offset:7168
    ds_read_b128 v[172:175], v192 offset:11264
    v_mul_f32 v16, v16, v176
    v_mul_f32 v17, v17, v177
    v_mul_f32 v18, v18, v178
    v_mul_f32 v19, v19, v179
    v_mul_f32 v20, v20, v180
    v_mul_f32 v21, v21, v181
    v_mul_f32 v22, v22, v182
    v_mul_f32 v23, v23, v183
    s_waitcnt lgkmcnt(4)
    v_add_f32 v136, v136, v152
    v_add_f32 v137, v137, v153
    v_add_f32 v138, v138, v154
    v_add_f32 v139, v139, v155
    s_waitcnt lgkmcnt(1)
    v_add_f32 v140, v140, v156
    v_add_f32 v141, v141, v157
    v_add_f32 v142, v142, v158
    v_add_f32 v143, v143, v159
    v_add_f32 v48, v48, v168
    v_add_f32 v49, v49, v169
    v_add_f32 v50, v50, v170
    v_add_f32 v51, v51, v171
    s_waitcnt lgkmcnt(0)
    v_add_f32 v52, v52, v172
    v_add_f32 v53, v53, v173
    v_add_f32 v54, v54, v174
    v_add_f32 v55, v55, v175
    v_add_f32 v48, v48, v136
    v_add_f32 v49, v49, v137
    v_add_f32 v50, v50, v138
    v_add_f32 v51, v51, v139
    v_add_f32 v52, v52, v140
    v_add_f32 v53, v53, v141
    v_add_f32 v54, v54, v142
    v_add_f32 v55, v55, v143
    v_mul_f32 v16, v16, v48
    v_mul_f32 v17, v17, v49
    v_mul_f32 v18, v18, v50
    v_mul_f32 v19, v19, v51
    v_mul_f32 v20, v20, v52
    v_mul_f32 v21, v21, v53
    v_mul_f32 v22, v22, v54
    v_mul_f32 v23, v23, v55
    v_permlane32_swap_b32 v16, v20
    v_permlane32_swap_b32 v17, v21
    v_permlane32_swap_b32 v18, v22
    v_permlane32_swap_b32 v19, v23
    v_add_f32 v16, v16, v184
    v_add_f32 v17, v17, v185
    v_add_f32 v18, v18, v186
    v_add_f32 v19, v19, v187
    v_add_f32 v20, v20, v188
    v_add_f32 v21, v21, v189
    v_add_f32 v22, v22, v190
    v_add_f32 v23, v23, v191
    v_cvt_pk_bf16_f32 v176, v16, v17
    v_cvt_pk_bf16_f32 v177, v18, v19
    v_cvt_pk_bf16_f32 v178, v20, v21
    v_cvt_pk_bf16_f32 v179, v22, v23
    buffer_store_dwordx4 v[176:179], v5, s[28:31], 0 offen
L_end:
    s_endpgm
L_att:
    s_lshl_b32 s97, s57, 2
    s_add_u32 s97, s97, s55
    s_mul_i32 s97, s97, 147456
    s_add_u32 s97, s97, 0x100000
    s_add_u32 s65, s64, 1024
    s_sub_u32 s66, s64, 1024
    s_lshl_b32 s98, s58, 1
    s_add_u32 s98, s98, s56
    s_mul_i32 s94, s98, 2304
    s_add_u32 s94, s94, 9216
    s_lshl_b32 s98, s98, 11
    s_add_u32 s68, s97, s98
    s_add_u32 s68, s68, 114688
    s_lshl_b32 s80, s56, 13
    s_lshl_b32 s96, s55, 11
    s_add_u32 s80, s80, s96
    s_add_u32 s80, s80, 0x21000
    s_lshl_b32 s81, s56, 9
    s_lshl_b32 s96, s55, 7
    s_add_u32 s81, s81, s96
    s_add_u32 s81, s81, 0x25000
    v_mov_b32 v64, 0
    v_mov_b32 v65, 0
    v_mov_b32 v66, 0
    v_mov_b32 v67, 0
    s_waitcnt vmcnt(4)
    s_barrier
    v_add_u32 v8, 0x10000, v8
    v_add_u32 v9, 0x10000, v9
    v_add_u32 v10, 0x10000, v10
    v_add_u32 v11, 0x10000, v11
    ds_read_b128 v[128:131], v8 offset:32768
    ds_read_b64_tr_b16 v[80:81], v72 offset:0
    ds_read_b64_tr_b16 v[82:83], v72 offset:512
    ds_read_b128 v[132:135], v9 offset:32768
    ds_read_b64_tr_b16 v[84:85], v72 offset:2048
    ds_read_b64_tr_b16 v[86:87], v72 offset:2560
    ds_read_b64_tr_b16 v[88:89], v72 offset:4096
    ds_read_b64_tr_b16 v[90:91], v72 offset:4608
    ds_read_b128 v[136:139], v10 offset:32768
    s_cmp_lg_u32 s2, 0
    s_waitcnt lgkmcnt(0)
    s_cbranch_scc1 L_nozf1
    s_cmp_lg_u32 s54, 0
    s_cbranch_scc1 L_nozf1
    v_mov_b32 v68, 1
    s_mov_b64 exec, 1
    buffer_store_dword v68, off, s[32:35], 0 sc1
    s_mov_b64 exec, -1
L_nozf1:
    v_mfma_f32_32x32x16_bf16 v[96:111], v[128:131], v[80:83], 0
    ds_read_b128 v[140:143], v11 offset:32768
    v_mfma_f32_16x16x32_bf16 v[20:23], v[16:19], v[80:83], 0
    ds_read_b64_tr_b16 v[92:93], v72 offset:6144
    ds_read_b64_tr_b16 v[94:95], v72 offset:6656
    s_add_u32 s74, s56, 0
    s_and_b32 s74, s74, 3
    s_lshl_b32 s74, s74, 7
    s_add_u32 s74, s74, s63
    s_add_u32 m0, s61, 0x20000
    s_add_u32 s73, s74, 0x200
    buffer_load_dwordx4 v1, s[8:11], s73 offen lds
    v_mfma_f32_32x32x16_bf16 v[96:111], v[132:135], v[84:87], v[96:111]
    ds_read_b128 v[144:147], v8 offset:49152
    v_mfma_f32_16x16x32_bf16 v[20:23], v[16:19], v[84:87], v[20:23]
    ds_read_b64_tr_b16 v[80:81], v73 offset:0
    ds_read_b64_tr_b16 v[82:83], v73 offset:512
    s_add_u32 s74, s56, 2
    s_and_b32 s74, s74, 3
    s_lshl_b32 s74, s74, 7
    s_add_u32 s74, s74, s63
    s_add_u32 m0, s61, 0x22000
    s_add_u32 s72, s74, 0x10200
    buffer_load_dwordx4 v1, s[8:11], s72 offen lds
    v_mfma_f32_32x32x16_bf16 v[96:111], v[136:139], v[88:91], v[96:111]
    ds_read_b128 v[148:151], v9 offset:49152
    v_mfma_f32_16x16x32_bf16 v[20:23], v[16:19], v[88:91], v[20:23]
    ds_read_b64_tr_b16 v[84:85], v73 offset:2048
    ds_read_b64_tr_b16 v[86:87], v73 offset:2560
    s_add_u32 s74, s56, 1
    s_and_b32 s74, s74, 3
    s_lshl_b32 s74, s74, 7
    s_add_u32 s74, s74, s63
    s_add_u32 m0, s61, 0x24000
    s_add_u32 s73, s74, 0x200
    buffer_load_dwordx4 v1, s[8:11], s73 offen lds
    s_waitcnt lgkmcnt(6)
    v_mfma_f32_32x32x16_bf16 v[96:111], v[140:143], v[92:95], v[96:111]
    ds_read_b128 v[152:155], v10 offset:49152
    v_mfma_f32_16x16x32_bf16 v[20:23], v[16:19], v[92:95], v[20:23]
    ds_read_b64_tr_b16 v[88:89], v73 offset:4096
    ds_read_b64_tr_b16 v[90:91], v73 offset:4608
    s_add_u32 s74, s56, 3
    s_and_b32 s74, s74, 3
    s_lshl_b32 s74, s74, 7
    s_add_u32 s74, s74, s63
    s_add_u32 m0, s61, 0x26000
    s_add_u32 s72, s74, 0x10200
    buffer_load_dwordx4 v1, s[8:11], s72 offen lds
    s_waitcnt lgkmcnt(6)
    v_mfma_f32_32x32x16_bf16 v[96:111], v[144:147], v[80:83], v[96:111]
    ds_read_b128 v[156:159], v11 offset:49152
    ds_read_b64_tr_b16 v[92:93], v73 offset:6144
    ds_read_b64_tr_b16 v[94:95], v73 offset:6656
    s_add_u32 m0, s62, 0x8000
    s_add_u32 s73, s64, 0xc0000
    buffer_load_dwordx4 v12, s[12:15], s73 offen lds
    s_waitcnt lgkmcnt(6)
    v_mfma_f32_32x32x16_bf16 v[96:111], v[148:151], v[84:87], v[96:111]
    ds_read_b64_tr_b16 v[80:81], v74 offset:0
    ds_read_b64_tr_b16 v[82:83], v74 offset:512
    s_add_u32 m0, s62, 0x8400
    s_add_u32 s72, s64, 0xc6000
    buffer_load_dwordx4 v12, s[12:15], s72 offen lds
    s_waitcnt lgkmcnt(5)
    v_mfma_f32_32x32x16_bf16 v[96:111], v[152:155], v[88:91], v[96:111]
    ds_read_b64_tr_b16 v[84:85], v74 offset:2048
    ds_read_b64_tr_b16 v[86:87], v74 offset:2560
    s_add_u32 m0, s62, 0x8800
    s_add_u32 s73, s64, 0xcc000
    buffer_load_dwordx4 v12, s[12:15], s73 offen lds
    s_waitcnt lgkmcnt(4)
    v_mfma_f32_32x32x16_bf16 v[96:111], v[156:159], v[92:95], v[96:111]
    ds_read_b64_tr_b16 v[88:89], v74 offset:4096
    ds_read_b64_tr_b16 v[90:91], v74 offset:4608
    s_add_u32 m0, s62, 0x8c00
    s_add_u32 s72, s64, 0xd2000
    buffer_load_dwordx4 v12, s[12:15], s72 offen lds
    s_cmp_eq_u32 s56, 0
    s_waitcnt lgkmcnt(0)
    s_cbranch_scc0 L_st_189
    v_dot2c_f32_bf16 v64, v128, v128
    v_dot2c_f32_bf16 v65, v129, v129
    v_dot2c_f32_bf16 v66, v130, v130
    v_dot2c_f32_bf16 v67, v131, v131
    v_dot2c_f32_bf16 v64, v132, v132
    v_dot2c_f32_bf16 v65, v133, v133
    v_dot2c_f32_bf16 v66, v134, v134
    v_dot2c_f32_bf16 v67, v135, v135
    v_dot2c_f32_bf16 v64, v136, v136
    v_dot2c_f32_bf16 v65, v137, v137
    v_dot2c_f32_bf16 v66, v138, v138
    v_dot2c_f32_bf16 v67, v139, v139
    v_dot2c_f32_bf16 v64, v140, v140
    v_dot2c_f32_bf16 v65, v141, v141
    v_dot2c_f32_bf16 v66, v142, v142
    v_dot2c_f32_bf16 v67, v143, v143
    v_dot2c_f32_bf16 v64, v144, v144
    v_dot2c_f32_bf16 v65, v145, v145
    v_dot2c_f32_bf16 v66, v146, v146
    v_dot2c_f32_bf16 v67, v147, v147
    v_dot2c_f32_bf16 v64, v148, v148
    v_dot2c_f32_bf16 v65, v149, v149
    v_dot2c_f32_bf16 v66, v150, v150
    v_dot2c_f32_bf16 v67, v151, v151
    v_dot2c_f32_bf16 v64, v152, v152
    v_dot2c_f32_bf16 v65, v153, v153
    v_dot2c_f32_bf16 v66, v154, v154
    v_dot2c_f32_bf16 v67, v155, v155
    v_dot2c_f32_bf16 v64, v156, v156
    v_dot2c_f32_bf16 v65, v157, v157
    v_dot2c_f32_bf16 v66, v158, v158
    v_dot2c_f32_bf16 v67, v159, v159
    s_branch L_ste_190
L_st_189:
    v_dot2c_f32_bf16 v64, s76, v128
    v_dot2c_f32_bf16 v65, s76, v129
    v_dot2c_f32_bf16 v66, s76, v130
    v_dot2c_f32_bf16 v67, s76, v131
    v_dot2c_f32_bf16 v64, s76, v132
    v_dot2c_f32_bf16 v65, s76, v133
    v_dot2c_f32_bf16 v66, s76, v134
    v_dot2c_f32_bf16 v67, s76, v135
    v_dot2c_f32_bf16 v64, s76, v136
    v_dot2c_f32_bf16 v65, s76, v137
    v_dot2c_f32_bf16 v66, s76, v138
    v_dot2c_f32_bf16 v67, s76, v139
    v_dot2c_f32_bf16 v64, s76, v140
    v_dot2c_f32_bf16 v65, s76, v141
    v_dot2c_f32_bf16 v66, s76, v142
    v_dot2c_f32_bf16 v67, s76, v143
    v_dot2c_f32_bf16 v64, s76, v144
    v_dot2c_f32_bf16 v65, s76, v145
    v_dot2c_f32_bf16 v66, s76, v146
    v_dot2c_f32_bf16 v67, s76, v147
    v_dot2c_f32_bf16 v64, s76, v148
    v_dot2c_f32_bf16 v65, s76, v149
    v_dot2c_f32_bf16 v66, s76, v150
    v_dot2c_f32_bf16 v67, s76, v151
    v_dot2c_f32_bf16 v64, s76, v152
    v_dot2c_f32_bf16 v65, s76, v153
    v_dot2c_f32_bf16 v66, s76, v154
    v_dot2c_f32_bf16 v67, s76, v155
    v_dot2c_f32_bf16 v64, s76, v156
    v_dot2c_f32_bf16 v65, s76, v157
    v_dot2c_f32_bf16 v66, s76, v158
    v_dot2c_f32_bf16 v67, s76, v159
L_ste_190:
    s_waitcnt vmcnt(8) lgkmcnt(0)
    s_barrier
    ds_read_b128 v[160:163], v8 offset:0
    ds_read_b128 v[164:167], v9 offset:0
    ds_read_b128 v[168:171], v10 offset:0
    s_waitcnt lgkmcnt(2)
    v_mfma_f32_32x32x16_bf16 v[96:111], v[160:163], v[80:83], v[96:111]
    ds_read_b128 v[172:175], v11 offset:0
    ds_read_b64_tr_b16 v[92:93], v74 offset:6144
    ds_read_b64_tr_b16 v[94:95], v74 offset:6656
    s_add_u32 s74, s56, 2
    s_and_b32 s74, s74, 3
    s_lshl_b32 s74, s74, 7
    s_add_u32 s74, s74, s63
    s_add_u32 m0, s61, 0x18000
    s_add_u32 s72, s74, 0x200
    buffer_load_dwordx4 v1, s[8:11], s72 offen lds
    s_waitcnt lgkmcnt(4)
    v_mfma_f32_32x32x16_bf16 v[96:111], v[164:167], v[84:87], v[96:111]
    ds_read_b128 v[176:179], v8 offset:16384
    ds_read_b64_tr_b16 v[80:81], v75 offset:0
    ds_read_b64_tr_b16 v[82:83], v75 offset:512
    s_add_u32 s74, s56, 4
    s_and_b32 s74, s74, 3
    s_lshl_b32 s74, s74, 7
    s_add_u32 s74, s74, s63
    s_add_u32 m0, s61, 0x1a000
    s_add_u32 s73, s74, 0x10200
    buffer_load_dwordx4 v1, s[8:11], s73 offen lds
    s_waitcnt lgkmcnt(6)
    v_mfma_f32_32x32x16_bf16 v[96:111], v[168:171], v[88:91], v[96:111]
    ds_read_b128 v[180:183], v9 offset:16384
    ds_read_b64_tr_b16 v[84:85], v75 offset:2048
    ds_read_b64_tr_b16 v[86:87], v75 offset:2560
    s_add_u32 s74, s56, 3
    s_and_b32 s74, s74, 3
    s_lshl_b32 s74, s74, 7
    s_add_u32 s74, s74, s63
    s_add_u32 m0, s61, 0x1c000
    s_add_u32 s72, s74, 0x200
    buffer_load_dwordx4 v1, s[8:11], s72 offen lds
    s_waitcnt lgkmcnt(6)
    v_mfma_f32_32x32x16_bf16 v[96:111], v[172:175], v[92:95], v[96:111]
    ds_read_b128 v[184:187], v10 offset:16384
    ds_read_b64_tr_b16 v[88:89], v75 offset:4096
    ds_read_b64_tr_b16 v[90:91], v75 offset:4608
    s_add_u32 s74, s56, 5
    s_and_b32 s74, s74, 3
    s_lshl_b32 s74, s74, 7
    s_add_u32 s74, s74, s63
    s_add_u32 m0, s61, 0x1e000
    s_add_u32 s73, s74, 0x10200
    buffer_load_dwordx4 v1, s[8:11], s73 offen lds
    s_waitcnt lgkmcnt(6)
    v_mfma_f32_32x32x16_bf16 v[96:111], v[176:179], v[80:83], v[96:111]
    ds_read_b128 v[188:191], v11 offset:16384
    ds_read_b64_tr_b16 v[92:93], v75 offset:6144
    ds_read_b64_tr_b16 v[94:95], v75 offset:6656
    s_waitcnt lgkmcnt(6)
    v_mfma_f32_32x32x16_bf16 v[96:111], v[180:183], v[84:87], v[96:111]
    v_lshrrev_b32 v49, 4, v2
    v_and_b32 v49, 7, v49
    v_lshrrev_b32 v50, 7, v2
    s_and_b32 s95, s57, 7
    s_lshl_b32 s95, s95, 6
    s_lshl_b32 s96, s54, 3
    s_add_u32 s95, s95, s96
    v_add_u32 v49, s95, v49
    s_movk_i32 s96, 3072
    v_mul_u32_u24 v49, s96, v49
    s_mul_i32 s97, s54, 98304
    s_sub_u32 s95, s65, s97
    v_mov_b32 v51, s95
    s_sub_u32 s95, s66, s97
    v_mov_b32 v52, s95
    v_cmp_eq_u32 vcc, 1, v50
    s_nop 1
    v_cndmask_b32 v51, v51, v52, vcc
    v_add_u32 v48, v49, v51
    s_mov_b32 exec_lo, 0xffff
    s_mov_b32 exec_hi, 0
    buffer_load_dword v0, v48, s[12:15], 0 offen
    s_mov_b64 exec, -1
    s_waitcnt lgkmcnt(3)
    v_mfma_f32_32x32x16_bf16 v[96:111], v[184:187], v[88:91], v[96:111]
    s_waitcnt lgkmcnt(0)
    v_mfma_f32_32x32x16_bf16 v[96:111], v[188:191], v[92:95], v[96:111]
    s_cmp_eq_u32 s56, 0
    s_cbranch_scc0 L_st_200
    v_dot2c_f32_bf16 v64, v160, v160
    v_dot2c_f32_bf16 v65, v161, v161
    v_dot2c_f32_bf16 v66, v162, v162
    v_dot2c_f32_bf16 v67, v163, v163
    v_dot2c_f32_bf16 v64, v164, v164
    v_dot2c_f32_bf16 v65, v165, v165
    v_dot2c_f32_bf16 v66, v166, v166
    v_dot2c_f32_bf16 v67, v167, v167
    v_dot2c_f32_bf16 v64, v168, v168
    v_dot2c_f32_bf16 v65, v169, v169
    v_dot2c_f32_bf16 v66, v170, v170
    v_dot2c_f32_bf16 v67, v171, v171
    v_dot2c_f32_bf16 v64, v172, v172
    v_dot2c_f32_bf16 v65, v173, v173
    v_dot2c_f32_bf16 v66, v174, v174
    v_dot2c_f32_bf16 v67, v175, v175
    v_dot2c_f32_bf16 v64, v176, v176
    v_dot2c_f32_bf16 v65, v177, v177
    v_dot2c_f32_bf16 v66, v178, v178
    v_dot2c_f32_bf16 v67, v179, v179
    v_dot2c_f32_bf16 v64, v180, v180
    v_dot2c_f32_bf16 v65, v181, v181
    v_dot2c_f32_bf16 v66, v182, v182
    v_dot2c_f32_bf16 v67, v183, v183
    v_dot2c_f32_bf16 v64, v184, v184
    v_dot2c_f32_bf16 v65, v185, v185
    v_dot2c_f32_bf16 v66, v186, v186
    v_dot2c_f32_bf16 v67, v187, v187
    v_dot2c_f32_bf16 v64, v188, v188
    v_dot2c_f32_bf16 v65, v189, v189
    v_dot2c_f32_bf16 v66, v190, v190
    v_dot2c_f32_bf16 v67, v191, v191
    s_branch L_ste_201
L_st_200:
    v_dot2c_f32_bf16 v64, s76, v160
    v_dot2c_f32_bf16 v65, s76, v161
    v_dot2c_f32_bf16 v66, s76, v162
    v_dot2c_f32_bf16 v67, s76, v163
    v_dot2c_f32_bf16 v64, s76, v164
    v_dot2c_f32_bf16 v65, s76, v165
    v_dot2c_f32_bf16 v66, s76, v166
    v_dot2c_f32_bf16 v67, s76, v167
    v_dot2c_f32_bf16 v64, s76, v168
    v_dot2c_f32_bf16 v65, s76, v169
    v_dot2c_f32_bf16 v66, s76, v170
    v_dot2c_f32_bf16 v67, s76, v171
    v_dot2c_f32_bf16 v64, s76, v172
    v_dot2c_f32_bf16 v65, s76, v173
    v_dot2c_f32_bf16 v66, s76, v174
    v_dot2c_f32_bf16 v67, s76, v175
    v_dot2c_f32_bf16 v64, s76, v176
    v_dot2c_f32_bf16 v65, s76, v177
    v_dot2c_f32_bf16 v66, s76, v178
    v_dot2c_f32_bf16 v67, s76, v179
    v_dot2c_f32_bf16 v64, s76, v180
    v_dot2c_f32_bf16 v65, s76, v181
    v_dot2c_f32_bf16 v66, s76, v182
    v_dot2c_f32_bf16 v67, s76, v183
    v_dot2c_f32_bf16 v64, s76, v184
    v_dot2c_f32_bf16 v65, s76, v185
    v_dot2c_f32_bf16 v66, s76, v186
    v_dot2c_f32_bf16 v67, s76, v187
    v_dot2c_f32_bf16 v64, s76, v188
    v_dot2c_f32_bf16 v65, s76, v189
    v_dot2c_f32_bf16 v66, s76, v190
    v_dot2c_f32_bf16 v67, s76, v191
L_ste_201:
    s_waitcnt vmcnt(4) lgkmcnt(0)
    s_barrier
    v_add_u32 v8, 0x10000, v8
    v_add_u32 v9, 0x10000, v9
    v_add_u32 v10, 0x10000, v10
    v_add_u32 v11, 0x10000, v11
    ds_read_b128 v[192:195], v8 offset:0
    ds_read_b64_tr_b16 v[80:81], v72 offset:32768
    ds_read_b64_tr_b16 v[82:83], v72 offset:33280
    ds_read_b128 v[196:199], v9 offset:0
    ds_read_b64_tr_b16 v[84:85], v72 offset:34816
    ds_read_b64_tr_b16 v[86:87], v72 offset:35328
    ds_read_b64_tr_b16 v[88:89], v72 offset:36864
    ds_read_b64_tr_b16 v[90:91], v72 offset:37376
    ds_read_b128 v[200:203], v10 offset:0
    s_waitcnt lgkmcnt(6)
    v_mfma_f32_32x32x16_bf16 v[96:111], v[192:195], v[80:83], v[96:111]
    ds_read_b128 v[204:207], v11 offset:0
    v_mfma_f32_16x16x32_bf16 v[20:23], v[16:19], v[80:83], v[20:23]
    ds_read_b64_tr_b16 v[92:93], v72 offset:38912
    ds_read_b64_tr_b16 v[94:95], v72 offset:39424
    s_mov_b32 m0, s62
    s_add_u32 s72, s65, 0x0
    buffer_load_dwordx4 v12, s[12:15], s72 offen lds
    s_waitcnt lgkmcnt(6)
    v_mfma_f32_32x32x16_bf16 v[96:111], v[196:199], v[84:87], v[96:111]
    ds_read_b128 v[208:211], v8 offset:16384
    v_mfma_f32_16x16x32_bf16 v[20:23], v[16:19], v[84:87], v[20:23]
    ds_read_b64_tr_b16 v[80:81], v73 offset:32768
    ds_read_b64_tr_b16 v[82:83], v73 offset:33280
    s_waitcnt lgkmcnt(6)
    v_mfma_f32_32x32x16_bf16 v[96:111], v[200:203], v[88:91], v[96:111]
    ds_read_b128 v[212:215], v9 offset:16384
    v_mfma_f32_16x16x32_bf16 v[20:23], v[16:19], v[88:91], v[20:23]
    ds_read_b64_tr_b16 v[84:85], v73 offset:34816
    ds_read_b64_tr_b16 v[86:87], v73 offset:35328
    s_add_u32 m0, s62, 0x400
    s_add_u32 s73, s65, 0x6000
    buffer_load_dwordx4 v12, s[12:15], s73 offen lds
    s_waitcnt lgkmcnt(6)
    v_mfma_f32_32x32x16_bf16 v[96:111], v[204:207], v[92:95], v[96:111]
    ds_read_b128 v[216:219], v10 offset:16384
    v_mfma_f32_16x16x32_bf16 v[20:23], v[16:19], v[92:95], v[20:23]
    ds_read_b64_tr_b16 v[88:89], v73 offset:36864
    ds_read_b64_tr_b16 v[90:91], v73 offset:37376
    s_waitcnt lgkmcnt(6)
    v_mfma_f32_32x32x16_bf16 v[96:111], v[208:211], v[80:83], v[96:111]
    ds_read_b128 v[220:223], v11 offset:16384
    ds_read_b64_tr_b16 v[92:93], v73 offset:38912
    ds_read_b64_tr_b16 v[94:95], v73 offset:39424
    s_add_u32 m0, s62, 0x800
    s_add_u32 s72, s65, 0xc000
    buffer_load_dwordx4 v12, s[12:15], s72 offen lds
    s_waitcnt lgkmcnt(6)
    v_mfma_f32_32x32x16_bf16 v[96:111], v[212:215], v[84:87], v[96:111]
    ds_read_b64_tr_b16 v[80:81], v74 offset:32768
    ds_read_b64_tr_b16 v[82:83], v74 offset:33280
    s_waitcnt lgkmcnt(5)
    v_mfma_f32_32x32x16_bf16 v[96:111], v[216:219], v[88:91], v[96:111]
    ds_read_b64_tr_b16 v[84:85], v74 offset:34816
    ds_read_b64_tr_b16 v[86:87], v74 offset:35328
    s_add_u32 m0, s62, 0xc00
    s_add_u32 s73, s65, 0x12000
    buffer_load_dwordx4 v12, s[12:15], s73 offen lds
    s_waitcnt lgkmcnt(4)
    v_mfma_f32_32x32x16_bf16 v[96:111], v[220:223], v[92:95], v[96:111]
    ds_read_b64_tr_b16 v[88:89], v74 offset:36864
    ds_read_b64_tr_b16 v[90:91], v74 offset:37376
    s_cmp_eq_u32 s56, 0
    s_waitcnt lgkmcnt(0)
    s_cbranch_scc0 L_st_210
    v_dot2c_f32_bf16 v64, v192, v192
    v_dot2c_f32_bf16 v65, v193, v193
    v_dot2c_f32_bf16 v66, v194, v194
    v_dot2c_f32_bf16 v67, v195, v195
    v_dot2c_f32_bf16 v64, v196, v196
    v_dot2c_f32_bf16 v65, v197, v197
    v_dot2c_f32_bf16 v66, v198, v198
    v_dot2c_f32_bf16 v67, v199, v199
    v_dot2c_f32_bf16 v64, v200, v200
    v_dot2c_f32_bf16 v65, v201, v201
    v_dot2c_f32_bf16 v66, v202, v202
    v_dot2c_f32_bf16 v67, v203, v203
    v_dot2c_f32_bf16 v64, v204, v204
    v_dot2c_f32_bf16 v65, v205, v205
    v_dot2c_f32_bf16 v66, v206, v206
    v_dot2c_f32_bf16 v67, v207, v207
    v_dot2c_f32_bf16 v64, v208, v208
    v_dot2c_f32_bf16 v65, v209, v209
    v_dot2c_f32_bf16 v66, v210, v210
    v_dot2c_f32_bf16 v67, v211, v211
    v_dot2c_f32_bf16 v64, v212, v212
    v_dot2c_f32_bf16 v65, v213, v213
    v_dot2c_f32_bf16 v66, v214, v214
    v_dot2c_f32_bf16 v67, v215, v215
    v_dot2c_f32_bf16 v64, v216, v216
    v_dot2c_f32_bf16 v65, v217, v217
    v_dot2c_f32_bf16 v66, v218, v218
    v_dot2c_f32_bf16 v67, v219, v219
    v_dot2c_f32_bf16 v64, v220, v220
    v_dot2c_f32_bf16 v65, v221, v221
    v_dot2c_f32_bf16 v66, v222, v222
    v_dot2c_f32_bf16 v67, v223, v223
    s_branch L_ste_211
L_st_210:
    v_dot2c_f32_bf16 v64, s76, v192
    v_dot2c_f32_bf16 v65, s76, v193
    v_dot2c_f32_bf16 v66, s76, v194
    v_dot2c_f32_bf16 v67, s76, v195
    v_dot2c_f32_bf16 v64, s76, v196
    v_dot2c_f32_bf16 v65, s76, v197
    v_dot2c_f32_bf16 v66, s76, v198
    v_dot2c_f32_bf16 v67, s76, v199
    v_dot2c_f32_bf16 v64, s76, v200
    v_dot2c_f32_bf16 v65, s76, v201
    v_dot2c_f32_bf16 v66, s76, v202
    v_dot2c_f32_bf16 v67, s76, v203
    v_dot2c_f32_bf16 v64, s76, v204
    v_dot2c_f32_bf16 v65, s76, v205
    v_dot2c_f32_bf16 v66, s76, v206
    v_dot2c_f32_bf16 v67, s76, v207
    v_dot2c_f32_bf16 v64, s76, v208
    v_dot2c_f32_bf16 v65, s76, v209
    v_dot2c_f32_bf16 v66, s76, v210
    v_dot2c_f32_bf16 v67, s76, v211
    v_dot2c_f32_bf16 v64, s76, v212
    v_dot2c_f32_bf16 v65, s76, v213
    v_dot2c_f32_bf16 v66, s76, v214
    v_dot2c_f32_bf16 v67, s76, v215
    v_dot2c_f32_bf16 v64, s76, v216
    v_dot2c_f32_bf16 v65, s76, v217
    v_dot2c_f32_bf16 v66, s76, v218
    v_dot2c_f32_bf16 v67, s76, v219
    v_dot2c_f32_bf16 v64, s76, v220
    v_dot2c_f32_bf16 v65, s76, v221
    v_dot2c_f32_bf16 v66, s76, v222
    v_dot2c_f32_bf16 v67, s76, v223
L_ste_211:
    s_waitcnt vmcnt(4) lgkmcnt(0)
    s_barrier
    v_add_u32 v8, 0xffff0000, v8
    v_add_u32 v9, 0xffff0000, v9
    v_add_u32 v10, 0xffff0000, v10
    v_add_u32 v11, 0xffff0000, v11
    ds_read_b128 v[224:227], v8 offset:32768
    ds_read_b128 v[228:231], v9 offset:32768
    ds_read_b128 v[232:235], v10 offset:32768
    s_waitcnt lgkmcnt(2)
    v_mfma_f32_32x32x16_bf16 v[96:111], v[224:227], v[80:83], v[96:111]
    ds_read_b128 v[236:239], v11 offset:32768
    ds_read_b64_tr_b16 v[92:93], v74 offset:38912
    ds_read_b64_tr_b16 v[94:95], v74 offset:39424
    s_add_u32 m0, s62, 0x10000
    s_add_u32 s73, s65, 0xc0000
    buffer_load_dwordx4 v12, s[12:15], s73 offen lds
    s_waitcnt lgkmcnt(4)
    v_mfma_f32_32x32x16_bf16 v[96:111], v[228:231], v[84:87], v[96:111]
    ds_read_b128 v[240:243], v8 offset:49152
    ds_read_b64_tr_b16 v[80:81], v75 offset:32768
    ds_read_b64_tr_b16 v[82:83], v75 offset:33280
    s_waitcnt lgkmcnt(6)
    v_mfma_f32_32x32x16_bf16 v[96:111], v[232:235], v[88:91], v[96:111]
    ds_read_b128 v[244:247], v9 offset:49152
    ds_read_b64_tr_b16 v[84:85], v75 offset:34816
    ds_read_b64_tr_b16 v[86:87], v75 offset:35328
    s_add_u32 m0, s62, 0x10400
    s_add_u32 s72, s65, 0xc6000
    buffer_load_dwordx4 v12, s[12:15], s72 offen lds
    s_waitcnt lgkmcnt(6)
    v_mfma_f32_32x32x16_bf16 v[96:111], v[236:239], v[92:95], v[96:111]
    ds_read_b128 v[248:251], v10 offset:49152
    ds_read_b64_tr_b16 v[88:89], v75 offset:36864
    ds_read_b64_tr_b16 v[90:91], v75 offset:37376
    s_waitcnt lgkmcnt(6)
    v_mfma_f32_32x32x16_bf16 v[96:111], v[240:243], v[80:83], v[96:111]
    ds_read_b128 v[252:255], v11 offset:49152
    ds_read_b64_tr_b16 v[92:93], v75 offset:38912
    ds_read_b64_tr_b16 v[94:95], v75 offset:39424
    s_add_u32 m0, s62, 0x10800
    s_add_u32 s73, s65, 0xcc000
    buffer_load_dwordx4 v12, s[12:15], s73 offen lds
    s_waitcnt lgkmcnt(6)
    v_mfma_f32_32x32x16_bf16 v[96:111], v[244:247], v[84:87], v[96:111]
    s_waitcnt lgkmcnt(3)
    v_mfma_f32_32x32x16_bf16 v[96:111], v[248:251], v[88:91], v[96:111]
    s_add_u32 m0, s62, 0x10c00
    s_add_u32 s72, s65, 0xd2000
    buffer_load_dwordx4 v12, s[12:15], s72 offen lds
    s_waitcnt lgkmcnt(0)
    v_mfma_f32_32x32x16_bf16 v[96:111], v[252:255], v[92:95], v[96:111]
    s_cmp_eq_u32 s56, 0
    s_cbranch_scc0 L_st_221
    v_dot2c_f32_bf16 v64, v224, v224
    v_dot2c_f32_bf16 v65, v225, v225
    v_dot2c_f32_bf16 v66, v226, v226
    v_dot2c_f32_bf16 v67, v227, v227
    v_dot2c_f32_bf16 v64, v228, v228
    v_dot2c_f32_bf16 v65, v229, v229
    v_dot2c_f32_bf16 v66, v230, v230
    v_dot2c_f32_bf16 v67, v231, v231
    v_dot2c_f32_bf16 v64, v232, v232
    v_dot2c_f32_bf16 v65, v233, v233
    v_dot2c_f32_bf16 v66, v234, v234
    v_dot2c_f32_bf16 v67, v235, v235
    v_dot2c_f32_bf16 v64, v236, v236
    v_dot2c_f32_bf16 v65, v237, v237
    v_dot2c_f32_bf16 v66, v238, v238
    v_dot2c_f32_bf16 v67, v239, v239
    v_dot2c_f32_bf16 v64, v240, v240
    v_dot2c_f32_bf16 v65, v241, v241
    v_dot2c_f32_bf16 v66, v242, v242
    v_dot2c_f32_bf16 v67, v243, v243
    v_dot2c_f32_bf16 v64, v244, v244
    v_dot2c_f32_bf16 v65, v245, v245
    v_dot2c_f32_bf16 v66, v246, v246
    v_dot2c_f32_bf16 v67, v247, v247
    v_dot2c_f32_bf16 v64, v248, v248
    v_dot2c_f32_bf16 v65, v249, v249
    v_dot2c_f32_bf16 v66, v250, v250
    v_dot2c_f32_bf16 v67, v251, v251
    v_dot2c_f32_bf16 v64, v252, v252
    v_dot2c_f32_bf16 v65, v253, v253
    v_dot2c_f32_bf16 v66, v254, v254
    v_dot2c_f32_bf16 v67, v255, v255
    s_branch L_ste_222
L_st_221:
    v_dot2c_f32_bf16 v64, s76, v224
    v_dot2c_f32_bf16 v65, s76, v225
    v_dot2c_f32_bf16 v66, s76, v226
    v_dot2c_f32_bf16 v67, s76, v227
    v_dot2c_f32_bf16 v64, s76, v228
    v_dot2c_f32_bf16 v65, s76, v229
    v_dot2c_f32_bf16 v66, s76, v230
    v_dot2c_f32_bf16 v67, s76, v231
    v_dot2c_f32_bf16 v64, s76, v232
    v_dot2c_f32_bf16 v65, s76, v233
    v_dot2c_f32_bf16 v66, s76, v234
    v_dot2c_f32_bf16 v67, s76, v235
    v_dot2c_f32_bf16 v64, s76, v236
    v_dot2c_f32_bf16 v65, s76, v237
    v_dot2c_f32_bf16 v66, s76, v238
    v_dot2c_f32_bf16 v67, s76, v239
    v_dot2c_f32_bf16 v64, s76, v240
    v_dot2c_f32_bf16 v65, s76, v241
    v_dot2c_f32_bf16 v66, s76, v242
    v_dot2c_f32_bf16 v67, s76, v243
    v_dot2c_f32_bf16 v64, s76, v244
    v_dot2c_f32_bf16 v65, s76, v245
    v_dot2c_f32_bf16 v66, s76, v246
    v_dot2c_f32_bf16 v67, s76, v247
    v_dot2c_f32_bf16 v64, s76, v248
    v_dot2c_f32_bf16 v65, s76, v249
    v_dot2c_f32_bf16 v66, s76, v250
    v_dot2c_f32_bf16 v67, s76, v251
    v_dot2c_f32_bf16 v64, s76, v252
    v_dot2c_f32_bf16 v65, s76, v253
    v_dot2c_f32_bf16 v66, s76, v254
    v_dot2c_f32_bf16 v67, s76, v255
L_ste_222:
    s_nop 0
    v_add_f32 v64, v64, v65
    s_nop 0
    v_add_f32 v66, v66, v67
    v_add_f32 v64, v64, v66
    v_mov_b32 v65, v64
    s_nop 0
    s_nop 0
    v_permlane32_swap_b32 v64, v65
    v_add_f32 v64, v64, v65
    s_lshl_b32 s95, s56, 9
    s_lshl_b32 s96, s55, 7
    s_add_u32 s95, s95, s96
    s_add_u32 s95, s95, 0x20000
    v_lshrrev_b32 v66, 4, v2
    v_and_b32 v66, 31, v66
    v_lshlrev_b32 v66, 2, v66
    v_add_u32 v67, s95, v66
    ds_write_b32 v67, v64
    ds_write_b32 v15, v20
    ds_write_b32 v15, v21 offset:256
    s_waitcnt vmcnt(4) lgkmcnt(0)
    s_barrier
    s_lshl_b32 s96, s55, 7
    s_add_u32 s96, s96, 0x20000
    v_add_u32 v67, s96, v66
    ds_read_b32 v68, v67
    ds_read_b32 v69, v67 offset:512
    ds_read_b64_tr_b16 v[80:81], v72 offset:0
    ds_read_b64_tr_b16 v[82:83], v72 offset:512
    ds_read_b64_tr_b16 v[84:85], v72 offset:2048
    ds_read_b64_tr_b16 v[86:87], v72 offset:2560
    ds_read_b64_tr_b16 v[88:89], v72 offset:4096
    ds_read_b64_tr_b16 v[90:91], v72 offset:4608
    v_lshrrev_b32 v9, 7, v2
    v_lshlrev_b32 v8, 3, v2
    v_and_b32 v8, 0x380, v8
    v_mul_u32_u24 v9, 0x30000, v9
    v_add_u32 v8, v8, v9
    s_lshl_b32 s97, s79, 3
    s_add_u32 s97, s97, s54
    s_lshr_b32 s98, s97, 6
    s_and_b32 s97, s97, 63
    s_mul_i32 s52, s98, 384
    s_add_u32 s52, s52, s97
    s_lshl_b32 s52, s52, 10
    s_mul_i32 s53, s98, 64
    s_add_u32 s53, s53, s97
    s_add_u32 s53, s53, 1536
    s_lshl_b32 s53, s53, 10
    s_mul_i32 s78, s98, 128
    s_add_u32 s78, s78, s97
    s_lshl_b32 s78, s78, 10
    s_waitcnt lgkmcnt(4)
    v_mfma_f32_32x32x16_bf16 v[112:127], v[128:131], v[80:83], 0
    v_mfma_f32_16x16x32_bf16 v[20:23], v[16:19], v[80:83], 0
    ds_read_b64_tr_b16 v[92:93], v72 offset:6144
    ds_read_b64_tr_b16 v[94:95], v72 offset:6656
    s_add_u32 m0, s62, 0x18000
    s_add_u32 s73, s66, 0x0
    buffer_load_dwordx4 v12, s[12:15], s73 offen lds
    s_waitcnt lgkmcnt(4)
    v_mfma_f32_32x32x16_bf16 v[112:127], v[132:135], v[84:87], v[112:127]
    v_mfma_f32_16x16x32_bf16 v[20:23], v[16:19], v[84:87], v[20:23]
    ds_read_b64_tr_b16 v[80:81], v73 offset:0
    ds_read_b64_tr_b16 v[82:83], v73 offset:512
    s_add_u32 m0, s62, 0x18400
    s_add_u32 s72, s66, 0x6000
    buffer_load_dwordx4 v12, s[12:15], s72 offen lds
    v_mul_f32 v69, 0x3b000000, v69
    v_mul_f32 v68, 0x3b000000, v68
    v_fma_f32 v68, -v69, v69, v68
    v_max_f32 v68, 0, v68
    v_add_f32 v68, 0x3727c5ac, v68
    s_waitcnt lgkmcnt(4)
    v_mfma_f32_32x32x16_bf16 v[112:127], v[136:139], v[88:91], v[112:127]
    v_mfma_f32_16x16x32_bf16 v[20:23], v[16:19], v[88:91], v[20:23]
    ds_read_b64_tr_b16 v[84:85], v73 offset:2048
    ds_read_b64_tr_b16 v[86:87], v73 offset:2560
    s_add_u32 m0, s62, 0x18800
    s_add_u32 s73, s66, 0xc000
    buffer_load_dwordx4 v12, s[12:15], s73 offen lds
    v_sqrt_f32 v14, v68
    v_rsq_f32 v68, v68
    v_sub_f32 v69, 0, v69
    v_mul_f32 v13, 0x3fb8aa3b, v68
    v_cvt_pk_bf16_f32 v24, v69, v69
    s_waitcnt lgkmcnt(4)
    v_mfma_f32_32x32x16_bf16 v[112:127], v[140:143], v[92:95], v[112:127]
    v_mfma_f32_16x16x32_bf16 v[20:23], v[16:19], v[92:95], v[20:23]
    ds_read_b64_tr_b16 v[88:89], v73 offset:4096
    ds_read_b64_tr_b16 v[90:91], v73 offset:4608
    s_add_u32 m0, s62, 0x18c00
    s_add_u32 s72, s66, 0x12000
    buffer_load_dwordx4 v12, s[12:15], s72 offen lds
    v_and_b32 v70, 0xffff0000, v24
    v_sub_f32 v70, v69, v70
    v_mov_b32 v71, 0
    v_cvt_pk_bf16_f32 v25, v70, v71
    s_lshl_b32 s96, s54, 7
    s_waitcnt lgkmcnt(4)
    v_mfma_f32_32x32x16_bf16 v[112:127], v[144:147], v[80:83], v[112:127]
    ds_read_b64_tr_b16 v[92:93], v73 offset:6144
    ds_read_b64_tr_b16 v[94:95], v73 offset:6656
    s_add_u32 m0, s62, 0x8000
    s_add_u32 s73, s66, 0xc0000
    buffer_load_dwordx4 v12, s[12:15], s73 offen lds
    s_add_u32 s96, s96, 0x20800
    v_add_u32 v67, s96, v66
    ds_write_b32 v67, v13
    v_lshrrev_b32 v70, 9, v2
    v_lshlrev_b32 v70, 4, v70
    v_add_u32 v70, s96, v70
    s_waitcnt lgkmcnt(5)
    v_mfma_f32_32x32x16_bf16 v[112:127], v[148:151], v[84:87], v[112:127]
    ds_read_b64_tr_b16 v[80:81], v74 offset:0
    ds_read_b64_tr_b16 v[82:83], v74 offset:512
    s_add_u32 m0, s62, 0x8400
    s_add_u32 s72, s66, 0xc6000
    buffer_load_dwordx4 v12, s[12:15], s72 offen lds
    ds_read_b128 v[32:35], v70 offset:0
    ds_read_b128 v[36:39], v70 offset:32
    ds_read_b128 v[40:43], v70 offset:64
    ds_read_b128 v[44:47], v70 offset:96
    v_mov_b32 v14, 0x358637bd
    s_waitcnt lgkmcnt(9)
    v_mfma_f32_32x32x16_bf16 v[112:127], v[152:155], v[88:91], v[112:127]
    ds_read_b64_tr_b16 v[84:85], v74 offset:2048
    ds_read_b64_tr_b16 v[86:87], v74 offset:2560
    s_add_u32 m0, s62, 0x8800
    s_add_u32 s73, s66, 0xcc000
    buffer_load_dwordx4 v12, s[12:15], s73 offen lds
    v_and_b32 v68, 0x1f0, v2
    v_add_u32 v68, s101, v68
    ds_read_b128 v[64:67], v68
    v_cmp_gt_u32 vcc, 512, v2
    s_waitcnt lgkmcnt(10)
    v_mfma_f32_32x32x16_bf16 v[112:127], v[156:159], v[92:95], v[112:127]
    ds_read_b64_tr_b16 v[88:89], v74 offset:4096
    ds_read_b64_tr_b16 v[90:91], v74 offset:4608
    s_add_u32 m0, s62, 0x8c00
    s_add_u32 s72, s66, 0xd2000
    buffer_load_dwordx4 v12, s[12:15], s72 offen lds
    s_waitcnt lgkmcnt(2)
    v_add_f32 v64, v64, v65
    v_add_f32 v66, v66, v67
    v_add_f32 v64, v64, v66
    v_cndmask_b32 v64, 0, v64, vcc
    v_mfma_f32_32x32x16_bf16 v[112:127], v[160:163], v[80:83], v[112:127]
    ds_read_b64_tr_b16 v[92:93], v74 offset:6144
    ds_read_b64_tr_b16 v[94:95], v74 offset:6656
    s_cmp_lg_u32 s54, 0
    s_cbranch_scc1 L_zfi_249
    buffer_load_dword v0, off, s[32:35], 0 sc1
L_zfi_249:
    v_cvt_pk_bf16_f32 v65, v64, v64
    v_and_b32 v65, 0xffff0000, v65
    v_sub_f32 v65, v64, v65
    v_cvt_pk_bf16_f32 v28, v64, v65
    v_and_b32 v29, 0xffff, v28
    v_mfma_f32_32x32x16_bf16 v[112:127], v[164:167], v[84:87], v[112:127]
    ds_read_b64_tr_b16 v[80:81], v75 offset:0
    ds_read_b64_tr_b16 v[82:83], v75 offset:512
    v_lshlrev_b32 v56, 3, v2
    s_lshl_b32 s97, s2, 3
    s_add_u32 s97, s97, s54
    s_mul_i32 s98, s97, 896
    s_mov_b32 m0, 0x25400
    s_lshl_b32 s97, s97, 8
    s_mov_b64 exec, 0x7f
    buffer_load_dword v56, s[16:19], s98 offen lds
    s_mov_b64 exec, 3
    buffer_load_dword v56, s[20:23], s97 offen lds
    s_mov_b64 exec, -1
    v_mfma_f32_32x32x16_bf16 v[96:111], v[24:27], v[28:31], v[96:111]
    s_waitcnt lgkmcnt(4)
    v_mfma_f32_32x32x16_bf16 v[112:127], v[168:171], v[88:91], v[112:127]
    ds_read_b64_tr_b16 v[84:85], v75 offset:2048
    ds_read_b64_tr_b16 v[86:87], v75 offset:2560
    s_waitcnt lgkmcnt(4)
    v_mfma_f32_32x32x16_bf16 v[112:127], v[172:175], v[92:95], v[112:127]
    ds_read_b64_tr_b16 v[88:89], v75 offset:4096
    ds_read_b64_tr_b16 v[90:91], v75 offset:4608
    s_nop 3
    v_mul_f32 v64, v32, v96
    v_mul_f32 v65, v33, v97
    v_exp_f32 v68, v64 clamp
    v_fmamk_f32 v64, v64, 0x3f317218, v14
    v_mul_f32 v66, v34, v98
    s_waitcnt lgkmcnt(4)
    v_mfma_f32_32x32x16_bf16 v[112:127], v[176:179], v[80:83], v[112:127]
    ds_read_b64_tr_b16 v[92:93], v75 offset:6144
    ds_read_b64_tr_b16 v[94:95], v75 offset:6656
    s_waitcnt vmcnt(10)
    s_barrier
    v_exp_f32 v69, v65 clamp
    v_fmamk_f32 v65, v65, 0x3f317218, v14
    v_max_f32 v64, v14, v64
    v_mul_f32 v67, v35, v99
    v_exp_f32 v70, v66 clamp
    s_waitcnt lgkmcnt(4)
    v_mfma_f32_32x32x16_bf16 v[112:127], v[180:183], v[84:87], v[112:127]
    ds_read_b64_tr_b16 v[80:81], v76 offset:0
    ds_read_b64_tr_b16 v[82:83], v76 offset:512
    v_fmamk_f32 v66, v66, 0x3f317218, v14
    v_max_f32 v65, v14, v65
    v_add_f32 v68, v64, v68
    v_mul_f32 v64, v36, v100
    v_exp_f32 v71, v67 clamp
    s_waitcnt lgkmcnt(4)
    v_mfma_f32_32x32x16_bf16 v[112:127], v[184:187], v[88:91], v[112:127]
    ds_read_b64_tr_b16 v[84:85], v76 offset:2048
    ds_read_b64_tr_b16 v[86:87], v76 offset:2560
    v_fmamk_f32 v67, v67, 0x3f317218, v14
    v_max_f32 v66, v14, v66
    v_add_f32 v69, v65, v69
    v_cvt_pk_bf16_f32 v48, v68, v69
    v_mul_f32 v65, v37, v101
    v_exp_f32 v68, v64 clamp
    s_waitcnt lgkmcnt(4)
    v_mfma_f32_32x32x16_bf16 v[112:127], v[188:191], v[92:95], v[112:127]
    ds_read_b64_tr_b16 v[88:89], v76 offset:4096
    ds_read_b64_tr_b16 v[90:91], v76 offset:4608
    v_fmamk_f32 v64, v64, 0x3f317218, v14
    v_max_f32 v67, v14, v67
    v_add_f32 v70, v66, v70
    v_mul_f32 v66, v38, v102
    v_exp_f32 v69, v65 clamp
    s_waitcnt lgkmcnt(4)
    v_mfma_f32_32x32x16_bf16 v[112:127], v[192:195], v[80:83], v[112:127]
    v_mfma_f32_16x16x32_bf16 v[20:23], v[16:19], v[80:83], v[20:23]
    ds_read_b64_tr_b16 v[92:93], v76 offset:6144
    ds_read_b64_tr_b16 v[94:95], v76 offset:6656
    v_fmamk_f32 v65, v65, 0x3f317218, v14
    v_max_f32 v64, v14, v64
    v_add_f32 v71, v67, v71
    v_cvt_pk_bf16_f32 v49, v70, v71
    v_mul_f32 v67, v39, v103
    s_waitcnt lgkmcnt(4)
    v_mfma_f32_32x32x16_bf16 v[112:127], v[196:199], v[84:87], v[112:127]
    v_mfma_f32_16x16x32_bf16 v[20:23], v[16:19], v[84:87], v[20:23]
    ds_read_b64_tr_b16 v[80:81], v77 offset:0
    ds_read_b64_tr_b16 v[82:83], v77 offset:512
    v_exp_f32 v70, v66 clamp
    v_fmamk_f32 v66, v66, 0x3f317218, v14
    v_max_f32 v65, v14, v65
    v_add_f32 v68, v64, v68
    v_mul_f32 v64, v40, v104
    s_waitcnt lgkmcnt(4)
    v_mfma_f32_32x32x16_bf16 v[112:127], v[200:203], v[88:91], v[112:127]
    v_mfma_f32_16x16x32_bf16 v[20:23], v[16:19], v[88:91], v[20:23]
    ds_read_b64_tr_b16 v[84:85], v77 offset:2048
    ds_read_b64_tr_b16 v[86:87], v77 offset:2560
    v_exp_f32 v71, v67 clamp
    v_fmamk_f32 v67, v67, 0x3f317218, v14
    v_max_f32 v66, v14, v66
    v_add_f32 v69, v65, v69
    v_cvt_pk_bf16_f32 v50, v68, v69
    v_mul_f32 v65, v41, v105
    s_waitcnt lgkmcnt(4)
    v_mfma_f32_32x32x16_bf16 v[112:127], v[204:207], v[92:95], v[112:127]
    v_mfma_f32_16x16x32_bf16 v[20:23], v[16:19], v[92:95], v[20:23]
    ds_read_b64_tr_b16 v[88:89], v77 offset:4096
    ds_read_b64_tr_b16 v[90:91], v77 offset:4608
    v_exp_f32 v68, v64 clamp
    v_fmamk_f32 v64, v64, 0x3f317218, v14
    v_max_f32 v67, v14, v67
    v_add_f32 v70, v66, v70
    v_mul_f32 v66, v42, v106
    s_waitcnt lgkmcnt(4)
    v_mfma_f32_32x32x16_bf16 v[112:127], v[208:211], v[80:83], v[112:127]
    ds_read_b64_tr_b16 v[92:93], v77 offset:6144
    ds_read_b64_tr_b16 v[94:95], v77 offset:6656
    v_exp_f32 v69, v65 clamp
    v_fmamk_f32 v65, v65, 0x3f317218, v14
    v_max_f32 v64, v14, v64
    v_add_f32 v71, v67, v71
    v_cvt_pk_bf16_f32 v51, v70, v71
    s_waitcnt lgkmcnt(4)
    v_mfma_f32_32x32x16_bf16 v[112:127], v[212:215], v[84:87], v[112:127]
    ds_read_b64_tr_b16 v[80:81], v78 offset:0
    ds_read_b64_tr_b16 v[82:83], v78 offset:512
    v_mul_f32 v67, v43, v107
    v_exp_f32 v70, v66 clamp
    v_fmamk_f32 v66, v66, 0x3f317218, v14
    v_max_f32 v65, v14, v65
    v_add_f32 v68, v64, v68
    s_waitcnt lgkmcnt(4)
    v_mfma_f32_32x32x16_bf16 v[112:127], v[216:219], v[88:91], v[112:127]
    ds_read_b64_tr_b16 v[84:85], v78 offset:2048
    ds_read_b64_tr_b16 v[86:87], v78 offset:2560
    v_mul_f32 v64, v44, v108
    v_exp_f32 v71, v67 clamp
    v_fmamk_f32 v67, v67, 0x3f317218, v14
    v_max_f32 v66, v14, v66
    v_add_f32 v69, v65, v69
    s_waitcnt lgkmcnt(4)
    v_mfma_f32_32x32x16_bf16 v[112:127], v[220:223], v[92:95], v[112:127]
    ds_read_b64_tr_b16 v[88:89], v78 offset:4096
    ds_read_b64_tr_b16 v[90:91], v78 offset:4608
    v_cvt_pk_bf16_f32 v52, v68, v69
    v_mul_f32 v65, v45, v109
    v_exp_f32 v68, v64 clamp
    v_fmamk_f32 v64, v64, 0x3f317218, v14
    v_max_f32 v67, v14, v67
    v_add_f32 v70, v66, v70
    s_waitcnt lgkmcnt(4)
    v_mfma_f32_32x32x16_bf16 v[112:127], v[224:227], v[80:83], v[112:127]
    ds_read_b64_tr_b16 v[92:93], v78 offset:6144
    ds_read_b64_tr_b16 v[94:95], v78 offset:6656
    s_mov_b32 m0, 0x25400
    s_add_u32 s97, s52, 0
    s_mov_b64 exec, 0xffff
    buffer_load_dword v8, s[16:19], s97 offen lds
    s_mov_b64 exec, -1
    v_mul_f32 v66, v46, v110
    v_exp_f32 v69, v65 clamp
    v_fmamk_f32 v65, v65, 0x3f317218, v14
    v_max_f32 v64, v14, v64
    v_add_f32 v71, v67, v71
    s_waitcnt lgkmcnt(4)
    v_mfma_f32_32x32x16_bf16 v[112:127], v[228:231], v[84:87], v[112:127]
    ds_read_b64_tr_b16 v[80:81], v79 offset:0
    ds_read_b64_tr_b16 v[82:83], v79 offset:512
    v_cvt_pk_bf16_f32 v53, v70, v71
    v_mul_f32 v67, v47, v111
    v_exp_f32 v70, v66 clamp
    v_fmamk_f32 v66, v66, 0x3f317218, v14
    v_max_f32 v65, v14, v65
    s_waitcnt lgkmcnt(4)
    v_mfma_f32_32x32x16_bf16 v[112:127], v[232:235], v[88:91], v[112:127]
    ds_read_b64_tr_b16 v[84:85], v79 offset:2048
    ds_read_b64_tr_b16 v[86:87], v79 offset:2560
    s_cmp_lg_u32 s54, 0
    s_waitcnt lgkmcnt(0)
    s_cbranch_scc1 L_zf_a_ok
    s_waitcnt vmcnt(3)
    v_readfirstlane_b32 s83, v0
    s_nop 0
    s_cmp_eq_u32 s83, 1
    s_cbranch_scc1 L_zf_a_ok
    s_mov_b32 s86, 0
    s_mov_b32 s75, 0
L_zf_a:
    buffer_load_dword v0, off, s[32:35], s75 sc1
    s_add_u32 s86, s86, 1
    s_waitcnt vmcnt(0)
    v_readfirstlane_b32 s83, v0
    s_cmp_gt_u32 s86, 0x10000
    s_cbranch_scc1 L_zf_a_to
    s_cmp_lg_u32 s83, 1
    s_cbranch_scc1 L_zf_a
L_zf_a_to:
L_zf_a_ok:
    v_add_f32 v68, v64, v68
    v_exp_f32 v71, v67 clamp
    v_fmamk_f32 v67, v67, 0x3f317218, v14
    v_max_f32 v66, v14, v66
    v_add_f32 v69, v65, v69
    v_mfma_f32_32x32x16_bf16 v[112:127], v[236:239], v[92:95], v[112:127]
    ds_read_b64_tr_b16 v[88:89], v79 offset:4096
    ds_read_b64_tr_b16 v[90:91], v79 offset:4608
    ds_write_b32 v15, v20
    ds_write_b32 v15, v21 offset:256
    v_cvt_pk_bf16_f32 v54, v68, v69
    v_max_f32 v67, v14, v67
    v_add_f32 v70, v66, v70
    v_add_f32 v71, v67, v71
    v_cvt_pk_bf16_f32 v55, v70, v71
    v_mfma_f32_32x32x16_bf16 v[112:127], v[240:243], v[80:83], v[112:127]
    ds_read_b64_tr_b16 v[92:93], v79 offset:6144
    ds_read_b64_tr_b16 v[94:95], v79 offset:6656
    s_waitcnt vmcnt(3)
    s_waitcnt lgkmcnt(2)
    s_barrier
    s_mov_b32 m0, s99
    s_add_u32 s72, s88, 0x0
    buffer_load_dwordx4 v3, s[16:19], s72 offen lds
    v_and_b32 v68, 0x1f0, v2
    v_add_u32 v68, s101, v68
    ds_read_b128 v[64:67], v68
    v_cmp_gt_u32 vcc, 512, v2
    v_mfma_f32_32x32x16_bf16 v[112:127], v[244:247], v[84:87], v[112:127]
    ds_read_b64_tr_b16 v[80:81], v76 offset:32768
    ds_read_b64_tr_b16 v[82:83], v76 offset:33280
    s_add_u32 m0, s99, 0x400
    s_add_u32 s73, s88, 0x2000
    buffer_load_dwordx4 v3, s[16:19], s73 offen lds
    s_waitcnt lgkmcnt(2)
    v_add_f32 v64, v64, v65
    v_add_f32 v66, v66, v67
    v_mfma_f32_32x32x16_bf16 v[112:127], v[248:251], v[88:91], v[112:127]
    ds_read_b64_tr_b16 v[84:85], v76 offset:34816
    ds_read_b64_tr_b16 v[86:87], v76 offset:35328
    s_add_u32 m0, s99, 0x800
    s_add_u32 s72, s88, 0x4000
    buffer_load_dwordx4 v3, s[16:19], s72 offen lds
    v_add_f32 v64, v64, v66
    v_cndmask_b32 v64, 0, v64, vcc
    v_cvt_pk_bf16_f32 v65, v64, v64
    v_and_b32 v65, 0xffff0000, v65
    v_sub_f32 v65, v64, v65
    v_mfma_f32_32x32x16_bf16 v[112:127], v[252:255], v[92:95], v[112:127]
    ds_read_b64_tr_b16 v[88:89], v76 offset:36864
    ds_read_b64_tr_b16 v[90:91], v76 offset:37376
    s_add_u32 m0, s99, 0xc00
    s_add_u32 s73, s88, 0x6000
    buffer_load_dwordx4 v3, s[16:19], s73 offen lds
    v_cvt_pk_bf16_f32 v28, v64, v65
    v_and_b32 v29, 0xffff, v28
    s_waitcnt lgkmcnt(4)
    v_mfma_f32_32x32x16_bf16 v[96:111], v[80:83], v[128:131], 0
    v_mfma_f32_16x16x32_bf16 v[20:23], v[16:19], v[80:83], 0
    ds_read_b64_tr_b16 v[92:93], v76 offset:38912
    ds_read_b64_tr_b16 v[94:95], v76 offset:39424
    v_mfma_f32_32x32x16_bf16 v[112:127], v[24:27], v[28:31], v[112:127]
    s_waitcnt lgkmcnt(4)
    v_mfma_f32_32x32x16_bf16 v[96:111], v[84:87], v[132:135], v[96:111]
    v_mfma_f32_16x16x32_bf16 v[20:23], v[16:19], v[84:87], v[20:23]
    ds_read_b64_tr_b16 v[80:81], v77 offset:32768
    ds_read_b64_tr_b16 v[82:83], v77 offset:33280
    s_nop 6
    v_mul_f32 v64, v32, v112
    s_waitcnt lgkmcnt(4)
    v_mfma_f32_32x32x16_bf16 v[96:111], v[88:91], v[136:139], v[96:111]
    v_mfma_f32_16x16x32_bf16 v[20:23], v[16:19], v[88:91], v[20:23]
    ds_read_b64_tr_b16 v[84:85], v77 offset:34816
    ds_read_b64_tr_b16 v[86:87], v77 offset:35328
    s_mov_b32 m0, 0x25400
    s_add_u32 s97, s52, 65536
    s_mov_b64 exec, 0xffff
    buffer_load_dword v8, s[16:19], s97 offen lds
    s_mov_b64 exec, -1
    v_mul_f32 v65, v33, v113
    v_mul_f32 v66, v34, v114
    v_mul_f32 v67, v35, v115
    v_cvt_pk_bf16_f32 v56, v64, v65
    v_cvt_pk_bf16_f32 v57, v66, v67
    s_waitcnt lgkmcnt(4)
    v_mfma_f32_32x32x16_bf16 v[96:111], v[92:95], v[140:143], v[96:111]
    v_mfma_f32_16x16x32_bf16 v[20:23], v[16:19], v[92:95], v[20:23]
    ds_read_b64_tr_b16 v[88:89], v77 offset:36864
    ds_read_b64_tr_b16 v[90:91], v77 offset:37376
    v_mul_f32 v64, v36, v116
    v_mul_f32 v65, v37, v117
    v_mul_f32 v66, v38, v118
    v_mul_f32 v67, v39, v119
    v_cvt_pk_bf16_f32 v58, v64, v65
    s_waitcnt lgkmcnt(4)
    v_mfma_f32_32x32x16_bf16 v[96:111], v[80:83], v[144:147], v[96:111]
    ds_read_b64_tr_b16 v[92:93], v77 offset:38912
    ds_read_b64_tr_b16 v[94:95], v77 offset:39424
    v_cvt_pk_bf16_f32 v59, v66, v67
    v_mul_f32 v64, v40, v120
    v_mul_f32 v65, v41, v121
    v_mul_f32 v66, v42, v122
    v_mul_f32 v67, v43, v123
    s_waitcnt lgkmcnt(4)
    v_mfma_f32_32x32x16_bf16 v[96:111], v[84:87], v[148:151], v[96:111]
    ds_read_b64_tr_b16 v[80:81], v78 offset:32768
    ds_read_b64_tr_b16 v[82:83], v78 offset:33280
    v_cvt_pk_bf16_f32 v60, v64, v65
    v_cvt_pk_bf16_f32 v61, v66, v67
    v_mul_f32 v64, v44, v124
    v_mul_f32 v65, v45, v125
    v_mul_f32 v66, v46, v126
    s_waitcnt lgkmcnt(4)
    v_mfma_f32_32x32x16_bf16 v[96:111], v[88:91], v[152:155], v[96:111]
    ds_read_b64_tr_b16 v[84:85], v78 offset:34816
    ds_read_b64_tr_b16 v[86:87], v78 offset:35328
    v_mul_f32 v67, v47, v127
    v_cvt_pk_bf16_f32 v62, v64, v65
    v_cvt_pk_bf16_f32 v63, v66, v67
    v_add_u32 v68, s80, v2
    v_mfma_f32_32x32x16_bf16 v[112:127], v[48:51], v[56:59], 0
    s_waitcnt lgkmcnt(4)
    v_mfma_f32_32x32x16_bf16 v[96:111], v[92:95], v[156:159], v[96:111]
    ds_read_b64_tr_b16 v[88:89], v78 offset:36864
    ds_read_b64_tr_b16 v[90:91], v78 offset:37376
    v_mfma_f32_32x32x16_bf16 v[112:127], v[52:55], v[60:63], v[112:127]
    v_mfma_f32_16x16x32_bf16 v[32:35], v[16:19], v[48:51], 0
    v_mfma_f32_16x16x32_bf16 v[32:35], v[16:19], v[52:55], v[32:35]
    v_lshrrev_b32 v69, 2, v2
    v_add_u32 v70, s81, v69
    s_waitcnt lgkmcnt(4)
    v_mfma_f32_32x32x16_bf16 v[96:111], v[80:83], v[160:163], v[96:111]
    ds_read_b64_tr_b16 v[92:93], v78 offset:38912
    ds_read_b64_tr_b16 v[94:95], v78 offset:39424
    v_cmp_gt_u32 vcc, 256, v2
    v_add_u32 v69, 0x25400, v69
    s_nop 0
    v_cndmask_b32 v69, v69, v70, vcc
    s_waitcnt lgkmcnt(4)
    v_mfma_f32_32x32x16_bf16 v[96:111], v[84:87], v[164:167], v[96:111]
    ds_read_b64_tr_b16 v[80:81], v79 offset:32768
    ds_read_b64_tr_b16 v[82:83], v79 offset:33280
    s_waitcnt lgkmcnt(4)
    v_mfma_f32_32x32x16_bf16 v[96:111], v[88:91], v[168:171], v[96:111]
    ds_read_b64_tr_b16 v[84:85], v79 offset:34816
    ds_read_b64_tr_b16 v[86:87], v79 offset:35328
    s_mov_b32 m0, 0x25400
    s_add_u32 s97, s52, 131072
    s_mov_b64 exec, 0xffff
    buffer_load_dword v8, s[16:19], s97 offen lds
    s_mov_b64 exec, -1
    v_cndmask_b32 v64, v120, v112, s[84:85]
    v_cndmask_b32 v65, v121, v113, s[84:85]
    v_cndmask_b32 v66, v122, v114, s[84:85]
    v_cndmask_b32 v67, v123, v115, s[84:85]
    v_mul_f32 v64, s87, v64
    s_waitcnt lgkmcnt(4)
    v_mfma_f32_32x32x16_bf16 v[96:111], v[92:95], v[172:175], v[96:111]
    ds_read_b64_tr_b16 v[88:89], v79 offset:36864
    ds_read_b64_tr_b16 v[90:91], v79 offset:37376
    v_mul_f32 v65, s87, v65
    v_mul_f32 v66, s87, v66
    v_mul_f32 v67, s87, v67
    ds_write_b128 v68, v[64:67] offset:0
    v_cndmask_b32 v64, v124, v116, s[84:85]
    s_waitcnt lgkmcnt(5)
    v_mfma_f32_32x32x16_bf16 v[96:111], v[80:83], v[176:179], v[96:111]
    ds_read_b64_tr_b16 v[92:93], v79 offset:38912
    ds_read_b64_tr_b16 v[94:95], v79 offset:39424
    v_cndmask_b32 v65, v125, v117, s[84:85]
    v_cndmask_b32 v66, v126, v118, s[84:85]
    v_cndmask_b32 v67, v127, v119, s[84:85]
    v_mul_f32 v64, s87, v64
    v_mul_f32 v65, s87, v65
    s_waitcnt lgkmcnt(5)
    v_mfma_f32_32x32x16_bf16 v[96:111], v[84:87], v[180:183], v[96:111]
    ds_read_b64_tr_b16 v[80:81], v72 offset:32768
    ds_read_b64_tr_b16 v[82:83], v72 offset:33280
    v_mul_f32 v66, s87, v66
    v_mul_f32 v67, s87, v67
    ds_write_b128 v68, v[64:67] offset:1024
    ds_write_b32 v69, v32
    ds_write_b32 v69, v33 offset:64
    s_waitcnt lgkmcnt(8)
    v_mfma_f32_32x32x16_bf16 v[96:111], v[88:91], v[184:187], v[96:111]
    ds_read_b64_tr_b16 v[84:85], v72 offset:34816
    ds_read_b64_tr_b16 v[86:87], v72 offset:35328
    s_waitcnt vmcnt(9)
    s_waitcnt lgkmcnt(2)
    s_barrier
    s_lshl_b32 s96, s56, 13
    s_lshr_b32 s97, s55, 1
    s_lshl_b32 s97, s97, 10
    s_add_u32 s96, s96, s97
    s_and_b32 s97, s55, 1
    s_lshl_b32 s97, s97, 3
    v_mfma_f32_32x32x16_bf16 v[96:111], v[92:95], v[188:191], v[96:111]
    ds_read_b64_tr_b16 v[88:89], v72 offset:36864
    ds_read_b64_tr_b16 v[90:91], v72 offset:37376
    s_add_u32 s96, s96, s97
    s_add_u32 s96, s96, 0x21000
    v_add_u32 v68, s96, v2
    ds_read_b64 v[32:33], v68 offset:0
    ds_read_b64 v[34:35], v68 offset:2048
    ds_read_b64 v[36:37], v68 offset:4096
    v_mfma_f32_32x32x16_bf16 v[96:111], v[80:83], v[192:195], v[96:111]
    v_mfma_f32_16x16x32_bf16 v[20:23], v[16:19], v[80:83], v[20:23]
    ds_read_b64_tr_b16 v[92:93], v72 offset:38912
    ds_read_b64_tr_b16 v[94:95], v72 offset:39424
    ds_read_b64 v[38:39], v68 offset:6144
    v_lshrrev_b32 v68, 2, v2
    s_lshl_b32 s96, s56, 9
    s_add_u32 s96, s96, 0x25000
    v_add_u32 v70, s96, v68
    ds_read_b32 v40, v70 offset:0
    s_waitcnt lgkmcnt(9)
    v_mfma_f32_32x32x16_bf16 v[96:111], v[84:87], v[196:199], v[96:111]
    v_mfma_f32_16x16x32_bf16 v[20:23], v[16:19], v[84:87], v[20:23]
    ds_read_b64_tr_b16 v[80:81], v73 offset:32768
    ds_read_b64_tr_b16 v[82:83], v73 offset:33280
    ds_read_b32 v41, v70 offset:128
    ds_read_b32 v42, v70 offset:256
    ds_read_b32 v43, v70 offset:384
    s_waitcnt lgkmcnt(12)
    v_mfma_f32_32x32x16_bf16 v[96:111], v[88:91], v[200:203], v[96:111]
    v_mfma_f32_16x16x32_bf16 v[20:23], v[16:19], v[88:91], v[20:23]
    ds_read_b64_tr_b16 v[84:85], v73 offset:34816
    ds_read_b64_tr_b16 v[86:87], v73 offset:35328
    s_waitcnt lgkmcnt(12)
    v_add_f32 v32, v32, v34
    s_waitcnt lgkmcnt(8)
    v_add_f32 v36, v36, v38
    v_add_f32 v33, v33, v35
    v_mfma_f32_32x32x16_bf16 v[96:111], v[92:95], v[204:207], v[96:111]
    v_mfma_f32_16x16x32_bf16 v[20:23], v[16:19], v[92:95], v[20:23]
    ds_read_b64_tr_b16 v[88:89], v73 offset:36864
    ds_read_b64_tr_b16 v[90:91], v73 offset:37376
    v_add_f32 v37, v37, v39
    v_add_f32 v64, v32, v36
    v_add_f32 v65, v33, v37
    s_waitcnt lgkmcnt(6)
    v_add_f32 v40, v40, v41
    s_waitcnt lgkmcnt(4)
    v_add_f32 v42, v42, v43
    v_add_f32 v66, v40, v42
    v_mfma_f32_32x32x16_bf16 v[96:111], v[80:83], v[208:211], v[96:111]
    ds_read_b64_tr_b16 v[92:93], v73 offset:38912
    ds_read_b64_tr_b16 v[94:95], v73 offset:39424
    s_lshl_b32 s96, s55, 9
    s_add_u32 s97, s94, s96
    buffer_atomic_add_f32 v64, v68, s[24:27], s97 offen
    buffer_atomic_add_f32 v65, v68, s[24:27], s97 offen offset:256
    s_cmp_lg_u32 s55, 0
    s_waitcnt lgkmcnt(0)
    s_cbranch_scc1 L_att_noz
    s_mov_b32 exec_hi, 0
    buffer_atomic_add_f32 v66, v68, s[24:27], s94 offen offset:2048
    s_mov_b64 exec, -1
L_att_noz:
    v_mfma_f32_32x32x16_bf16 v[96:111], v[84:87], v[212:215], v[96:111]
    ds_read_b64_tr_b16 v[80:81], v74 offset:32768
    ds_read_b64_tr_b16 v[82:83], v74 offset:33280
    v_mfma_f32_32x32x16_bf16 v[96:111], v[88:91], v[216:219], v[96:111]
    ds_read_b64_tr_b16 v[84:85], v74 offset:34816
    ds_read_b64_tr_b16 v[86:87], v74 offset:35328
    s_add_u32 m0, s99, 0x10000
    s_add_u32 s73, s88, 0x30000
    buffer_load_dwordx4 v3, s[16:19], s73 offen lds
    v_mfma_f32_32x32x16_bf16 v[96:111], v[92:95], v[220:223], v[96:111]
    ds_read_b64_tr_b16 v[88:89], v74 offset:36864
    ds_read_b64_tr_b16 v[90:91], v74 offset:37376
    s_add_u32 m0, s99, 0x10400
    s_add_u32 s72, s88, 0x32000
    buffer_load_dwordx4 v3, s[16:19], s72 offen lds
    s_waitcnt lgkmcnt(4)
    v_mfma_f32_32x32x16_bf16 v[96:111], v[80:83], v[224:227], v[96:111]
    ds_read_b64_tr_b16 v[92:93], v74 offset:38912
    ds_read_b64_tr_b16 v[94:95], v74 offset:39424
    s_add_u32 m0, s99, 0x10800
    s_add_u32 s73, s88, 0x34000
    buffer_load_dwordx4 v3, s[16:19], s73 offen lds
    s_waitcnt lgkmcnt(4)
    v_mfma_f32_32x32x16_bf16 v[96:111], v[84:87], v[228:231], v[96:111]
    ds_read_b64_tr_b16 v[80:81], v75 offset:32768
    ds_read_b64_tr_b16 v[82:83], v75 offset:33280
    s_add_u32 m0, s99, 0x10c00
    s_add_u32 s72, s88, 0x36000
    buffer_load_dwordx4 v3, s[16:19], s72 offen lds
    s_waitcnt lgkmcnt(4)
    v_mfma_f32_32x32x16_bf16 v[96:111], v[88:91], v[232:235], v[96:111]
    ds_read_b64_tr_b16 v[84:85], v75 offset:34816
    ds_read_b64_tr_b16 v[86:87], v75 offset:35328
    s_waitcnt lgkmcnt(4)
    v_mfma_f32_32x32x16_bf16 v[96:111], v[92:95], v[236:239], v[96:111]
    ds_read_b64_tr_b16 v[88:89], v75 offset:36864
    ds_read_b64_tr_b16 v[90:91], v75 offset:37376
    ds_write_b32 v15, v20
    ds_write_b32 v15, v21 offset:256
    s_mov_b32 m0, 0x25400
    s_add_u32 s97, s53, 0
    s_mov_b64 exec, 0xff
    buffer_load_dword v8, s[16:19], s97 offen lds
    s_mov_b64 exec, -1
    s_waitcnt lgkmcnt(6)
    v_mfma_f32_32x32x16_bf16 v[96:111], v[80:83], v[240:243], v[96:111]
    ds_read_b64_tr_b16 v[92:93], v75 offset:38912
    ds_read_b64_tr_b16 v[94:95], v75 offset:39424
    s_waitcnt vmcnt(16)
    s_waitcnt lgkmcnt(2)
    s_barrier
    s_add_u32 m0, s99, 0x18000
    s_add_u32 s73, s88, 0x10000
    buffer_load_dwordx4 v3, s[16:19], s73 offen lds
    v_mfma_f32_32x32x16_bf16 v[96:111], v[84:87], v[244:247], v[96:111]
    s_add_u32 m0, s99, 0x18400
    s_add_u32 s72, s88, 0x12000
    buffer_load_dwordx4 v3, s[16:19], s72 offen lds
    v_mfma_f32_32x32x16_bf16 v[96:111], v[88:91], v[248:251], v[96:111]
    s_add_u32 m0, s99, 0x18800
    s_add_u32 s73, s88, 0x14000
    buffer_load_dwordx4 v3, s[16:19], s73 offen lds
    s_waitcnt lgkmcnt(0)
    v_mfma_f32_32x32x16_bf16 v[96:111], v[92:95], v[252:255], v[96:111]
    s_add_u32 m0, s99, 0x18c00
    s_add_u32 s72, s88, 0x16000
    buffer_load_dwordx4 v3, s[16:19], s72 offen lds
    s_lshl_b32 s80, s58, 7
    s_cmp_lg_u32 s54, 0
    s_cbranch_scc1 L_p0i_277
    s_add_u32 s75, s92, 1024
    buffer_load_dword v0, off, s[24:27], s75 sc1
L_p0i_277:
    v_and_b32 v68, 0x1f0, v2
    v_add_u32 v68, s101, v68
    ds_read_b128 v[64:67], v68
    v_cmp_gt_u32 vcc, 512, v2
    s_waitcnt lgkmcnt(0)
    v_add_f32 v64, v64, v65
    v_add_f32 v66, v66, v67
    v_add_f32 v64, v64, v66
    v_cndmask_b32 v64, 0, v64, vcc
    v_cvt_pk_bf16_f32 v65, v64, v64
    v_and_b32 v65, 0xffff0000, v65
    v_sub_f32 v65, v64, v65
    v_cvt_pk_bf16_f32 v28, v64, v65
    v_and_b32 v29, 0xffff, v28
    s_nop 0
    s_nop 0
    v_mfma_f32_32x32x16_bf16 v[96:111], v[28:31], v[24:27], v[96:111]
    s_nop 11
    v_mul_f32 v64, v13, v96
    v_mul_f32 v65, v13, v97
    v_exp_f32 v68, v64 clamp
    v_fmamk_f32 v64, v64, 0x3f317218, v14
    v_mul_f32 v66, v13, v98
    v_exp_f32 v69, v65 clamp
    v_fmamk_f32 v65, v65, 0x3f317218, v14
    v_max_f32 v64, v14, v64
    v_mul_f32 v67, v13, v99
    v_exp_f32 v70, v66 clamp
    v_fmamk_f32 v66, v66, 0x3f317218, v14
    v_max_f32 v65, v14, v65
    v_add_f32 v68, v64, v68
    v_mul_f32 v64, v13, v100
    v_exp_f32 v71, v67 clamp
    v_fmamk_f32 v67, v67, 0x3f317218, v14
    v_max_f32 v66, v14, v66
    v_add_f32 v69, v65, v69
    v_cvt_pk_bf16_f32 v32, v68, v69
    v_mul_f32 v65, v13, v101
    v_exp_f32 v68, v64 clamp
    v_fmamk_f32 v64, v64, 0x3f317218, v14
    v_max_f32 v67, v14, v67
    v_add_f32 v70, v66, v70
    v_mul_f32 v66, v13, v102
    v_exp_f32 v69, v65 clamp
    v_fmamk_f32 v65, v65, 0x3f317218, v14
    v_max_f32 v64, v14, v64
    v_add_f32 v71, v67, v71
    v_cvt_pk_bf16_f32 v33, v70, v71
    v_mul_f32 v67, v13, v103
    v_exp_f32 v70, v66 clamp
    v_fmamk_f32 v66, v66, 0x3f317218, v14
    v_max_f32 v65, v14, v65
    v_add_f32 v68, v64, v68
    v_mul_f32 v64, v13, v104
    v_exp_f32 v71, v67 clamp
    v_fmamk_f32 v67, v67, 0x3f317218, v14
    v_max_f32 v66, v14, v66
    v_add_f32 v69, v65, v69
    v_cvt_pk_bf16_f32 v34, v68, v69
    v_mul_f32 v65, v13, v105
    v_exp_f32 v68, v64 clamp
    v_fmamk_f32 v64, v64, 0x3f317218, v14
    v_max_f32 v67, v14, v67
    v_add_f32 v70, v66, v70
    v_mul_f32 v66, v13, v106
    v_exp_f32 v69, v65 clamp
    v_fmamk_f32 v65, v65, 0x3f317218, v14
    v_max_f32 v64, v14, v64
    v_add_f32 v71, v67, v71
    v_cvt_pk_bf16_f32 v35, v70, v71
    v_mul_f32 v67, v13, v107
    v_exp_f32 v70, v66 clamp
    v_fmamk_f32 v66, v66, 0x3f317218, v14
    v_max_f32 v65, v14, v65
    v_add_f32 v68, v64, v68
    v_mul_f32 v64, v13, v108
    v_exp_f32 v71, v67 clamp
    v_fmamk_f32 v67, v67, 0x3f317218, v14
    s_cmp_lg_u32 s54, 0
    s_cbranch_scc1 L_pa1a_ok
    s_waitcnt vmcnt(0)
    v_readfirstlane_b32 s83, v0
    s_nop 0
    s_cmp_eq_u32 s83, 8
    s_cbranch_scc1 L_pa1a_ok
    s_mov_b32 s86, 0
    s_add_u32 s75, s92, 1024
L_pa1a:
    buffer_load_dword v0, off, s[24:27], s75 sc1
    s_add_u32 s86, s86, 1
    s_waitcnt vmcnt(0)
    v_readfirstlane_b32 s83, v0
    s_cmp_gt_u32 s86, 0x10000
    s_cbranch_scc1 L_pa1a_to
    s_cmp_lg_u32 s83, 8
    s_cbranch_scc1 L_pa1a
L_pa1a_to:
L_pa1a_ok:
    s_waitcnt vmcnt(9)
    s_barrier
    s_cmp_lg_u32 s54, 0
    s_cbranch_scc1 L_sigkv
    s_add_u32 s75, s80, 0
    v_mov_b32 v10, 1
    s_mov_b64 exec, 1
    buffer_atomic_add v10, off, s[24:27], s75
    s_mov_b64 exec, -1
L_sigkv:
    s_mov_b32 m0, 0x25400
    s_add_u32 s97, s78, 0
    s_mov_b64 exec, 0xff
    buffer_load_dword v8, s[20:23], s97 offen lds
    s_mov_b64 exec, -1
    v_max_f32 v66, v14, v66
    v_add_f32 v69, v65, v69
    v_cvt_pk_bf16_f32 v36, v68, v69
    v_mul_f32 v65, v13, v109
    v_exp_f32 v68, v64 clamp
    v_fmamk_f32 v64, v64, 0x3f317218, v14
    v_max_f32 v67, v14, v67
    v_add_f32 v70, v66, v70
    v_mul_f32 v66, v13, v110
    v_exp_f32 v69, v65 clamp
    v_fmamk_f32 v65, v65, 0x3f317218, v14
    v_max_f32 v64, v14, v64
    v_add_f32 v71, v67, v71
    v_cvt_pk_bf16_f32 v37, v70, v71
    v_mul_f32 v67, v13, v111
    v_exp_f32 v70, v66 clamp
    v_fmamk_f32 v66, v66, 0x3f317218, v14
    v_max_f32 v65, v14, v65
    v_add_f32 v68, v64, v68
    v_exp_f32 v71, v67 clamp
    v_fmamk_f32 v67, v67, 0x3f317218, v14
    v_max_f32 v66, v14, v66
    v_add_f32 v69, v65, v69
    v_cvt_pk_bf16_f32 v38, v68, v69
    v_max_f32 v67, v14, v67
    v_add_f32 v70, v66, v70
    v_add_f32 v71, v67, v71
    v_cvt_pk_bf16_f32 v39, v70, v71
    s_mov_b32 m0, 0x25400
    s_add_u32 s97, s78, 65536
    s_mov_b64 exec, 0xff
    buffer_load_dword v8, s[20:23], s97 offen lds
    s_mov_b64 exec, -1
    s_add_u32 s74, s90, 0
    buffer_load_dwordx4 v[128:131], v2, s[24:27], s74 offen offset:0 sc1
    buffer_load_dwordx4 v[132:135], v2, s[24:27], s74 offen offset:1024 sc1
    buffer_load_dwordx4 v[136:139], v2, s[24:27], s74 offen offset:2048 sc1
    buffer_load_dwordx4 v[140:143], v2, s[24:27], s74 offen offset:3072 sc1
    s_add_u32 s74, s90, 12288
    buffer_load_dwordx4 v[144:147], v2, s[24:27], s74 offen offset:0 sc1
    buffer_load_dwordx4 v[148:151], v2, s[24:27], s74 offen offset:1024 sc1
    buffer_load_dwordx4 v[152:155], v2, s[24:27], s74 offen offset:2048 sc1
    buffer_load_dwordx4 v[156:159], v2, s[24:27], s74 offen offset:3072 sc1
    s_cmp_lg_u32 s54, 0
    s_cbranch_scc1 L_pa2a_ok
    s_mov_b32 s86, 0
    s_add_u32 s75, s92, 3072
L_pa2a:
    buffer_load_dword v0, off, s[24:27], s75 sc1
    s_add_u32 s86, s86, 1
    s_waitcnt vmcnt(0)
    v_readfirstlane_b32 s83, v0
    s_cmp_gt_u32 s86, 0x10000
    s_cbranch_scc1 L_pa2a_to
    s_cmp_lg_u32 s83, 8
    s_cbranch_scc1 L_pa2a
L_pa2a_to:
L_pa2a_ok:
    s_cmp_lg_u32 s54, 0
    s_cbranch_scc1 L_kvpoll_ok
    s_mov_b32 s86, 0
    s_add_u32 s75, s80, 0
L_kvpoll:
    buffer_load_dword v0, off, s[24:27], s75 sc1
    s_add_u32 s86, s86, 1
    s_waitcnt vmcnt(0)
    v_readfirstlane_b32 s83, v0
    s_cmp_gt_u32 s86, 0x10000
    s_cbranch_scc1 L_kvpoll_to
    s_cmp_lg_u32 s83, 16
    s_cbranch_scc1 L_kvpoll
L_kvpoll_to:
L_kvpoll_ok:
    s_barrier
    v_lshrrev_b32 v15, 2, v2
    buffer_load_dword v104, v15, s[24:27], s94 offen offset:0 sc1
    buffer_load_dword v105, v15, s[24:27], s94 offen offset:256 sc1
    buffer_load_dword v106, v15, s[24:27], s94 offen offset:512 sc1
    buffer_load_dword v107, v15, s[24:27], s94 offen offset:768 sc1
    buffer_load_dword v108, v15, s[24:27], s94 offen offset:1024 sc1
    buffer_load_dword v109, v15, s[24:27], s94 offen offset:1280 sc1
    buffer_load_dword v110, v15, s[24:27], s94 offen offset:1536 sc1
    buffer_load_dword v111, v15, s[24:27], s94 offen offset:1792 sc1
    v_lshrrev_b32 v6, 9, v2
    v_lshlrev_b32 v6, 4, v6
    v_add_u32 v7, 64, v6
    v_cndmask_b32 v6, v6, v7, s[84:85]
    buffer_load_dwordx4 v[96:99], v6, s[24:27], s94 offen offset:2048 sc1
    buffer_load_dwordx4 v[100:103], v6, s[24:27], s94 offen offset:2080 sc1
    s_waitcnt vmcnt(0)
    v_cndmask_b32 v48, v96, v104, s[84:85]
    v_cndmask_b32 v56, v104, v96, s[84:85]
    v_cndmask_b32 v49, v97, v105, s[84:85]
    v_cndmask_b32 v57, v105, v97, s[84:85]
    v_cndmask_b32 v50, v98, v106, s[84:85]
    v_cndmask_b32 v58, v106, v98, s[84:85]
    v_cndmask_b32 v51, v99, v107, s[84:85]
    v_cndmask_b32 v59, v107, v99, s[84:85]
    v_cndmask_b32 v52, v100, v108, s[84:85]
    v_cndmask_b32 v60, v108, v100, s[84:85]
    v_cndmask_b32 v53, v101, v109, s[84:85]
    v_cndmask_b32 v61, v109, v101, s[84:85]
    v_cndmask_b32 v54, v102, v110, s[84:85]
    v_cndmask_b32 v62, v110, v102, s[84:85]
    v_cndmask_b32 v55, v103, v111, s[84:85]
    v_cndmask_b32 v63, v111, v103, s[84:85]
    v_cvt_pk_bf16_f32 v120, v48, v49
    v_cvt_pk_bf16_f32 v124, v56, v57
    v_cvt_pk_bf16_f32 v121, v50, v51
    v_cvt_pk_bf16_f32 v125, v58, v59
    v_cvt_pk_bf16_f32 v122, v52, v53
    v_cvt_pk_bf16_f32 v126, v60, v61
    v_cvt_pk_bf16_f32 v123, v54, v55
    v_cvt_pk_bf16_f32 v127, v62, v63
    s_nop 0
    v_mfma_f32_32x32x16_bf16 v[48:63], v[120:123], v[32:35], 0
    v_mfma_f32_32x32x16_bf16 v[64:79], v[124:127], v[36:39], 0
    s_nop 10
    v_add_f32 v104, 0x358637bd, v56
    v_add_f32 v105, 0x358637bd, v64
    v_rcp_f32 v104, v104
    v_rcp_f32 v105, v105
    v_mul_f32 v48, v104, v48
    v_mul_f32 v72, v105, v72
    v_mul_f32 v49, v104, v49
    v_mul_f32 v73, v105, v73
    v_mul_f32 v50, v104, v50
    v_mul_f32 v74, v105, v74
    v_mul_f32 v51, v104, v51
    v_mul_f32 v75, v105, v75
    v_mul_f32 v52, v104, v52
    v_mul_f32 v76, v105, v76
    v_mul_f32 v53, v104, v53
    v_mul_f32 v77, v105, v77
    v_mul_f32 v54, v104, v54
    v_mul_f32 v78, v105, v78
    v_mul_f32 v55, v104, v55
    v_mul_f32 v79, v105, v79
    v_cvt_pk_bf16_f32 v96, v48, v49
    v_cvt_pk_bf16_f32 v100, v72, v73
    v_cvt_pk_bf16_f32 v97, v50, v51
    v_cvt_pk_bf16_f32 v101, v74, v75
    v_cvt_pk_bf16_f32 v98, v52, v53
    v_cvt_pk_bf16_f32 v102, v76, v77
    v_cvt_pk_bf16_f32 v99, v54, v55
    v_cvt_pk_bf16_f32 v103, v78, v79
    buffer_store_dwordx4 v[96:99], v2, s[24:27], s68 offen sc1
    buffer_store_dwordx4 v[100:103], v2, s[24:27], s68 offen offset:1024 sc1
    s_branch L_s2
L_code_end:
.section .rodata,"a"
.p2align 6
.amdhsa_kernel recurrent_scan__linear_attn_block__dense_activation_silu__prompt_kernel
  .amdhsa_next_free_vgpr 256
  .amdhsa_next_free_sgpr 102
  .amdhsa_accum_offset 256
  .amdhsa_group_segment_fixed_size 0
  .amdhsa_kernarg_size 72
  .amdhsa_user_sgpr_count 2
  .amdhsa_user_sgpr_kernarg_segment_ptr 1
  .amdhsa_system_sgpr_workgroup_id_x 1
.end_amdhsa_kernel
```
